```python
import torch

def _softmax(x, axis=-1):
    return torch.softmax(x, dim=axis)
def _gelu(x):
    return torch.nn.functional.gelu(x, approximate="tanh")
def _silu(x):
    return torch.nn.functional.silu(x)
def _sigmoid(x):
    return torch.sigmoid(x)
def _layernorm(x, axis=-1, eps=1e-5):
    m = x.mean(dim=axis, keepdim=True)
    v = x.var(dim=axis, keepdim=True, unbiased=False)
    return (x - m) / torch.sqrt(v + eps)
def _scatter_add(tgt, idx, src, axis=0):
    return tgt.clone().index_add_(axis, idx, src)
def _segment_sum(src, seg, n):
    out = torch.zeros((n,) + src.shape[1:], dtype=src.dtype)
    return out.index_add_(0, seg, src)
def _pad(x, pw):
    flat = tuple(v for pair in reversed(pw) for v in pair)
    return torch.nn.functional.pad(x, flat)

kernel_name = 'recurrent_scan__ssm_conv_s4__dense_activation_gelu__prompt'

def setup_inputs():

    _w = (lambda a: (lambda t: t.to(torch.bfloat16) if t.is_floating_point() else t)(torch.as_tensor(a)))
    def _A_setup():
        B, L, D, N = 1, 2048, 640, 192
        A_re = -(lambda _x: torch.exp(torch.as_tensor(_x)))((lambda *s: torch.randn(*s, dtype=torch.bfloat16) * 3.2)(D, N))
        A_im = torch.pi * (lambda *s: torch.randn(*s, dtype=torch.bfloat16) * 0.2)(D, N)
        B_re = (lambda *s: torch.randn(*s, dtype=torch.bfloat16) * 0.2)(D, N)
        B_im = (lambda *s: torch.randn(*s, dtype=torch.bfloat16) * 0.2)(D, N)
        C_re = (lambda *s: torch.randn(*s, dtype=torch.bfloat16) * 0.2)(D, N)
        C_im = (lambda *s: torch.randn(*s, dtype=torch.bfloat16) * 0.2)(D, N)
        log_dt = (lambda *s: torch.randn(*s, dtype=torch.bfloat16) * 0.2)(D) * 0.5 - 4.0
        Dskip = (lambda *s: torch.randn(*s, dtype=torch.bfloat16) * 0.2)(D)
        return {
            "u": _w((lambda *s: torch.randn(*s, dtype=torch.bfloat16) * 0.05)(B, L, D)),
            "A_re": _w(A_re),
            "A_im": _w(A_im),
            "B_re": _w(B_re),
            "B_im": _w(B_im),
            "C_re": _w(C_re),
            "C_im": _w(C_im),
            "log_dt": _w(log_dt),
            "Dskip": _w(Dskip),
        }
    _A_in = _A_setup()

    def _B_setup():
        B, S, D, F = 1, 2048, 640, 1536
        return {
            "x": _w((lambda *s: torch.randn(*s, dtype=torch.bfloat16) * 0.05)(B, S, D)),
            "w1": _w((lambda *s: torch.randn(*s, dtype=torch.bfloat16) * 0.8)(D, F) * (D ** -0.5)),
            "b1": _w((lambda *s: torch.randn(*s, dtype=torch.bfloat16) * 0.1)(F) * 0.01),
            "w2": _w((lambda *s: torch.randn(*s, dtype=torch.bfloat16) * 0.1)(F, D) * (F ** -0.5)),
            "b2": _w((lambda *s: torch.randn(*s, dtype=torch.bfloat16) * 0.1)(D) * 0.01),
        }
    _B_in = _B_setup()

    return {
        "A_u": _A_in["u"],
        "A_A_re": _A_in["A_re"],
        "A_A_im": _A_in["A_im"],
        "A_B_re": _A_in["B_re"],
        "A_B_im": _A_in["B_im"],
        "A_C_re": _A_in["C_re"],
        "A_C_im": _A_in["C_im"],
        "A_log_dt": _A_in["log_dt"],
        "A_Dskip": _A_in["Dskip"],
        "B_x": _B_in["x"],
        "B_w1": _B_in["w1"],
        "B_b1": _B_in["b1"],
        "B_w2": _B_in["w2"],
        "B_b2": _B_in["b2"],
    }

def reference(A_u, A_A_re, A_A_im, A_B_re, A_B_im, A_C_re, A_C_im, A_log_dt, A_Dskip, B_x, B_w1, B_b1, B_w2, B_b2):
    def _A_ref(u, A_re, A_im, B_re, B_im, C_re, C_im, log_dt, Dskip):
        Bsz, L, D = u.shape
        dt = torch.exp(log_dt)[:, None]
        A = A_re + 1j * A_im
        Bc = B_re + 1j * B_im
        Cc = C_re + 1j * C_im
        logdA = dt * A
        dB = dt * Bc
        l = (lambda x, dt: x.to(dt))(torch.arange(L), A_re.dtype)
        P = torch.exp(logdA[:, :, None] * l[None, None, :])
        K = torch.einsum("dn,dnl,dn->dl", Cc, P, dB).real
        L2 = 2 * L
        Kp = _pad(K, ((0, 0), (0, L)))
        up = (lambda x, *d: x.permute(*d))(u, 0, 2, 1)
        up = _pad(up, ((0, 0), (0, 0), (0, L)))
        Kf = (lambda x, axes=(-2,-1): torch.fft.rfft2(x.float(), dim=axes))(Kp[:, None, :], axes=(-2, -1))
        Uf = (lambda x, axes=(-2,-1): torch.fft.rfft2(x.float(), dim=axes))(up[:, :, None, :], axes=(-2, -1))
        Yf = Uf * Kf[None, :, :, :]
        y = (lambda x, s, axes=(-2,-1): torch.fft.irfft2(x, s=s, dim=axes).to(torch.bfloat16))(Yf, (1, L2), axes=(-2, -1))[:, :, 0, :L]
        y = (lambda x, *d: x.permute(*d))(y, 0, 2, 1) + u * Dskip[None, None, :]
        return y

    def _B_ref(x, w1, b1, w2, b2):
        h = torch.einsum("bsd,df->bsf", x, w1) + b1
        h = _gelu(h)
        return torch.einsum("bsf,fd->bsd", h, w2) + b2

    x = A_u
    xn = _layernorm(x, axis=-1)
    s = _A_ref(xn, A_A_re, A_A_im, A_B_re, A_B_im, A_C_re, A_C_im, A_log_dt, A_Dskip)
    g = _silu(_B_ref(xn, B_w1, B_b1, B_w2, B_b2))
    return x + s * g
```

```asm
; @launch grid=(256,1,1) block=(512,1,1) lds=163840
.amdgcn_target "amdgcn-amd-amdhsa--gfx950"
.text
.globl recurrent_scan__ssm_conv_s4__dense_activation_gelu__prompt_kernel
.p2align 8
.type recurrent_scan__ssm_conv_s4__dense_activation_gelu__prompt_kernel,@function
recurrent_scan__ssm_conv_s4__dense_activation_gelu__prompt_kernel:
    s_cmp_ge_u32 s2, 0x100
    s_cbranch_scc1 L_end
    s_load_dwordx16 s[8:23], s[0:1], 0
    s_load_dwordx16 s[24:39], s[0:1], 64
    s_load_dwordx2 s[44:45], s[0:1], 128
    s_getpc_b64 s[42:43]
L_pc:
    s_lshl_b32 s7, s2, 10
    s_and_b32 s7, s7, 0xe000
    v_lshrrev_b32 v1, 6, v0
    v_and_b32 v127, 63, v0
    v_lshl_add_u32 v2, v1, 10, s7
    v_lshl_add_u32 v2, v127, 7, v2
    v_min_u32 v2, L_codeend-L_pc-4, v2
    s_mov_b64 exec, 0xff
    global_load_dword v120, v2, s[42:43]
    s_mov_b64 exec, -1
    v_lshlrev_b32 v2, 2, v127
    v_add_u32 v2, 163328, v2
    v_mov_b32 v3, 0
    ds_write_b32 v2, v3
    ds_write_b32 v2, v3 offset:256
    v_readfirstlane_b32 s78, v1
    v_lshlrev_b32 v126, 4, v127
    s_and_b32 s65, s2, 7
    s_lshr_b32 s66, s2, 3
    s_and_b32 s3, s78, 3
    s_lshr_b32 s67, s65, 1
    s_and_b32 s68, s65, 1
    s_lshl_b32 s4, s67, 2
    s_and_b32 s69, s66, 3
    s_add_u32 s4, s4, s69
    s_lshl_b32 s5, s68, 3
    s_lshr_b32 s7, s66, 2
    s_add_u32 s5, s5, s7
    s_lshl_b32 s6, s4, 4
    s_add_u32 s6, s6, s5
    s_mul_i32 s7, s7, 5
    s_and_b32 s77, s7, 0xfc
    s_lshl_b32 s62, s67, 3
    s_and_b32 s7, s66, 7
    s_add_u32 s62, s62, s7
    s_mul_i32 s7, s7, 3
    s_lshr_b32 s51, s7, 1
    s_lshl_b32 s63, s68, 2
    s_lshr_b32 s7, s66, 3
    s_add_u32 s63, s63, s7
    s_mov_b32 s47, 0x20000
    s_mov_b32 s46, 18874368
    s_waitcnt lgkmcnt(0)
    s_barrier
    s_cmp_ge_u32 s78, 4
    s_cbranch_scc1 L_S
    s_setprio 1
    v_lshrrev_b32 v1, 5, v127
    v_and_b32 v2, 31, v127
    v_mul_u32_u24 v3, 1280, v1
    v_lshl_add_u32 v3, v2, 3, v3
    s_lshl_b32 s65, s6, 2
    s_add_u32 s65, s65, s3
    s_mul_i32 s7, s65, 2560
    v_add_u32 v3, s7, v3
    global_load_dwordx2 v[8:9], v3, s[8:9] offset:0
    global_load_dwordx2 v[10:11], v3, s[8:9] offset:256
    global_load_dwordx2 v[12:13], v3, s[8:9] offset:512
    global_load_dwordx2 v[14:15], v3, s[8:9] offset:768
    global_load_dwordx2 v[16:17], v3, s[8:9] offset:1024
    s_lshr_b32 s7, s65, 2
    s_lshl_b32 s7, s7, 7
    s_and_b32 s79, s65, 3
    s_lshl_b32 s79, s79, 2
    s_add_u32 s79, s79, s7
    s_add_u32 s79, s79, 16252928
    s_or_b32 s7, s2, s3
    s_cmp_lg_u32 s7, 0
    s_cbranch_scc1 L_noepw
    s_memrealtime s[70:71]
    s_waitcnt lgkmcnt(0)
    s_or_b32 s70, s70, 1
    v_mov_b32 v4, s70
    s_mov_b64 exec, 1
    global_store_dword v126, v4, s[38:39] sc1
    s_mov_b64 exec, -1
L_noepw:
    v_lshrrev_b32 v4, 4, v127
    s_mul_i32 s7, s3, 2688
    s_add_u32 s7, s7, 139008
    v_mul_u32_u24 v7, 1344, v1
    v_lshl_add_u32 v7, v2, 3, v7
    v_add_u32 v7, s7, v7
    v_and_b32 v1, 7, v127
    v_lshrrev_b32 v2, 3, v127
    v_mul_u32_u24 v97, 1344, v1
    v_lshl_add_u32 v97, v2, 4, v97
    s_lshl_b32 s7, s3, 7
    s_add_u32 s7, s7, 139008
    v_add_u32 v97, s7, v97
    v_lshlrev_b32 v98, 9, v2
    v_lshl_add_u32 v98, v1, 4, v98
    v_bfe_u32 v99, v127, 2, 2
    v_sub_u32 v99, 3, v99
    v_mul_u32_u24 v99, 1344, v99
    v_lshl_add_u32 v99, v4, 5, v99
    v_and_b32 v1, 3, v127
    v_lshl_add_u32 v99, v1, 3, v99
    v_add_u32 v99, s7, v99
    s_lshr_b32 s75, s6, 2
    s_mul_i32 s75, s75, 40960
    s_and_b32 s7, s6, 3
    s_lshl_b32 s7, s7, 7
    s_add_u32 s75, s75, s7
    s_lshl_b32 s7, s3, 12
    s_add_u32 s75, s75, s7
    s_mul_i32 s26, s6, 10240
    s_lshl_b32 s7, s3, 10
    s_add_u32 s26, s26, s7
    s_add_u32 s26, s26, 2621440
    s_cmp_lt_u32 s3, 2
    s_cselect_b32 s27, 0, 1879048192
    s_mov_b32 s67, 0x3f803f80
    s_mov_b32 s68, 0x00003f80
    s_mov_b32 s69, 0x3f800000
    v_mov_b32 v4, 0
    v_mov_b32 v5, 0
    s_waitcnt vmcnt(0)
    v_dot2_f32_bf16 v4, v8, s67, v4
    v_dot2_f32_bf16 v5, v8, v8, v5
    v_dot2_f32_bf16 v4, v9, s67, v4
    v_dot2_f32_bf16 v5, v9, v9, v5
    v_dot2_f32_bf16 v4, v10, s67, v4
    v_dot2_f32_bf16 v5, v10, v10, v5
    v_dot2_f32_bf16 v4, v11, s67, v4
    v_dot2_f32_bf16 v5, v11, v11, v5
    v_dot2_f32_bf16 v4, v12, s67, v4
    v_dot2_f32_bf16 v5, v12, v12, v5
    v_dot2_f32_bf16 v4, v13, s67, v4
    v_dot2_f32_bf16 v5, v13, v13, v5
    v_dot2_f32_bf16 v4, v14, s67, v4
    v_dot2_f32_bf16 v5, v14, v14, v5
    v_dot2_f32_bf16 v4, v15, s67, v4
    v_dot2_f32_bf16 v5, v15, v15, v5
    v_dot2_f32_bf16 v4, v16, s67, v4
    v_dot2_f32_bf16 v5, v16, v16, v5
    v_dot2_f32_bf16 v4, v17, s67, v4
    v_dot2_f32_bf16 v5, v17, v17, v5
    s_cmp_lg_u32 s3, 0
    s_cbranch_scc1 L_noepl
    s_mov_b64 exec, 1
    global_load_dword v101, v126, s[38:39] sc1
    s_mov_b64 exec, -1
L_noepl:
    s_nop 0
    v_add_f32_dpp v4, v4, v4 row_ror:1 row_mask:0xf bank_mask:0xf
    v_add_f32_dpp v5, v5, v5 row_ror:1 row_mask:0xf bank_mask:0xf
    s_nop 0
    v_add_f32_dpp v4, v4, v4 row_ror:2 row_mask:0xf bank_mask:0xf
    v_add_f32_dpp v5, v5, v5 row_ror:2 row_mask:0xf bank_mask:0xf
    s_nop 0
    v_add_f32_dpp v4, v4, v4 row_ror:4 row_mask:0xf bank_mask:0xf
    v_add_f32_dpp v5, v5, v5 row_ror:4 row_mask:0xf bank_mask:0xf
    s_nop 0
    v_add_f32_dpp v4, v4, v4 row_ror:8 row_mask:0xf bank_mask:0xf
    v_add_f32_dpp v5, v5, v5 row_ror:8 row_mask:0xf bank_mask:0xf
    v_mov_b32 v28, v4
    v_mov_b32 v29, v5
    s_nop 0
    v_permlane16_swap_b32 v4, v28
    v_permlane16_swap_b32 v5, v29
    v_add_f32 v4, v4, v28
    v_add_f32 v5, v5, v29
    v_mul_f32 v4, 0x3acccccd, v4
    v_mul_f32 v5, 0x3acccccd, v5
    v_fma_f32 v5, -v4, v4, v5
    v_max_f32 v5, 0, v5
    v_cvt_pk_bf16_f32 v28, -v4, v5
    v_lshlrev_b32 v4, 16, v28
    v_and_b32 v5, 0xffff0000, v28
    v_add_f32 v5, 0x3727c5ac, v5
    v_cvt_pk_bf16_f32 v5, v5, v5
    v_and_b32 v5, 0xffff0000, v5
    v_sqrt_f32 v5, v5
    v_dot2_f32_bf16 v32, v8, s68, v4
    v_dot2_f32_bf16 v33, v8, s69, v4
    v_dot2_f32_bf16 v34, v9, s68, v4
    v_dot2_f32_bf16 v35, v9, s69, v4
    v_dot2_f32_bf16 v36, v10, s68, v4
    v_dot2_f32_bf16 v37, v10, s69, v4
    v_dot2_f32_bf16 v38, v11, s68, v4
    v_dot2_f32_bf16 v39, v11, s69, v4
    v_dot2_f32_bf16 v40, v12, s68, v4
    v_dot2_f32_bf16 v41, v12, s69, v4
    v_dot2_f32_bf16 v42, v13, s68, v4
    v_dot2_f32_bf16 v43, v13, s69, v4
    v_dot2_f32_bf16 v44, v14, s68, v4
    v_dot2_f32_bf16 v45, v14, s69, v4
    v_dot2_f32_bf16 v46, v15, s68, v4
    v_dot2_f32_bf16 v47, v15, s69, v4
    v_dot2_f32_bf16 v48, v16, s68, v4
    v_dot2_f32_bf16 v49, v16, s69, v4
    v_dot2_f32_bf16 v50, v17, s68, v4
    v_dot2_f32_bf16 v51, v17, s69, v4
    v_cvt_pk_bf16_f32 v5, v5, v5
    v_and_b32 v5, 0xffff0000, v5
    v_rcp_f32 v30, v5
    v_cvt_pk_bf16_f32 v8, v32, v33
    v_cvt_pk_bf16_f32 v9, v34, v35
    v_cvt_pk_bf16_f32 v10, v36, v37
    v_cvt_pk_bf16_f32 v11, v38, v39
    v_cvt_pk_bf16_f32 v12, v40, v41
    v_cvt_pk_bf16_f32 v13, v42, v43
    v_cvt_pk_bf16_f32 v14, v44, v45
    v_cvt_pk_bf16_f32 v15, v46, v47
    v_cvt_pk_bf16_f32 v16, v48, v49
    v_cvt_pk_bf16_f32 v17, v50, v51
    v_lshlrev_b32 v32, 16, v8
    v_and_b32 v33, 0xffff0000, v8
    v_lshlrev_b32 v34, 16, v9
    v_and_b32 v35, 0xffff0000, v9
    v_lshlrev_b32 v36, 16, v10
    v_and_b32 v37, 0xffff0000, v10
    v_lshlrev_b32 v38, 16, v11
    v_and_b32 v39, 0xffff0000, v11
    v_lshlrev_b32 v40, 16, v12
    v_and_b32 v41, 0xffff0000, v12
    v_lshlrev_b32 v42, 16, v13
    v_and_b32 v43, 0xffff0000, v13
    v_lshlrev_b32 v44, 16, v14
    v_and_b32 v45, 0xffff0000, v14
    v_lshlrev_b32 v46, 16, v15
    v_and_b32 v47, 0xffff0000, v15
    v_lshlrev_b32 v48, 16, v16
    v_and_b32 v49, 0xffff0000, v16
    v_lshlrev_b32 v50, 16, v17
    v_and_b32 v51, 0xffff0000, v17
    v_pk_mul_f32 v[32:33], v[32:33], v[30:31] op_sel_hi:[1,0]
    v_pk_mul_f32 v[34:35], v[34:35], v[30:31] op_sel_hi:[1,0]
    v_cvt_pk_bf16_f32 v8, v32, v33
    v_cvt_pk_bf16_f32 v9, v34, v35
    ds_write_b64 v7, v[8:9] offset:0
    v_pk_mul_f32 v[36:37], v[36:37], v[30:31] op_sel_hi:[1,0]
    v_pk_mul_f32 v[38:39], v[38:39], v[30:31] op_sel_hi:[1,0]
    v_cvt_pk_bf16_f32 v10, v36, v37
    v_cvt_pk_bf16_f32 v11, v38, v39
    ds_write_b64 v7, v[10:11] offset:256
    v_pk_mul_f32 v[40:41], v[40:41], v[30:31] op_sel_hi:[1,0]
    v_pk_mul_f32 v[42:43], v[42:43], v[30:31] op_sel_hi:[1,0]
    v_cvt_pk_bf16_f32 v12, v40, v41
    v_cvt_pk_bf16_f32 v13, v42, v43
    ds_write_b64 v7, v[12:13] offset:512
    v_pk_mul_f32 v[44:45], v[44:45], v[30:31] op_sel_hi:[1,0]
    v_pk_mul_f32 v[46:47], v[46:47], v[30:31] op_sel_hi:[1,0]
    v_cvt_pk_bf16_f32 v14, v44, v45
    v_cvt_pk_bf16_f32 v15, v46, v47
    ds_write_b64 v7, v[14:15] offset:768
    v_pk_mul_f32 v[48:49], v[48:49], v[30:31] op_sel_hi:[1,0]
    v_pk_mul_f32 v[50:51], v[50:51], v[30:31] op_sel_hi:[1,0]
    v_cvt_pk_bf16_f32 v16, v48, v49
    v_cvt_pk_bf16_f32 v17, v50, v51
    ds_write_b64 v7, v[16:17] offset:1024
    s_lshl_b32 s72, s3, 2
    s_add_u32 s72, s72, 163360
    v_mov_b32 v124, s72
    ds_write_b32 v124, v124
    v_and_b32 v124, 3, v127
    v_lshlrev_b32 v124, 2, v124
    v_add_u32 v124, 163360, v124
    s_mov_b32 s73, 0
L_lw1:
    ds_read_b32 v125, v124
    s_add_u32 s73, s73, 1
    s_waitcnt lgkmcnt(0)
    v_cmp_eq_u32 vcc, 0, v125
    s_nop 1
    s_cbranch_vccz L_lw1_ok
    s_sleep 1
    s_cmp_lt_u32 s73, 3200000
    s_cbranch_scc1 L_lw1
L_lw1_ok:
    ds_read_b128 v[32:35], v97 offset:0
    ds_read_b128 v[36:39], v97 offset:512
    ds_read_b128 v[40:43], v97 offset:1024
    ds_read_b64_tr_b16 v[44:45], v99 offset:5376
    ds_read_b64_tr_b16 v[46:47], v99 offset:0
    ds_read_b64_tr_b16 v[48:49], v99 offset:5888
    ds_read_b64_tr_b16 v[50:51], v99 offset:512
    ds_read_b64_tr_b16 v[52:53], v99 offset:6400
    ds_read_b64_tr_b16 v[54:55], v99 offset:1024
    s_waitcnt lgkmcnt(8)
    buffer_store_dwordx4 v[32:35], v98, s[44:47], s75 offen sc1
    s_add_u32 s75, s75, 16384
    s_waitcnt lgkmcnt(7)
    buffer_store_dwordx4 v[36:39], v98, s[44:47], s75 offen sc1
    s_add_u32 s75, s75, 16384
    s_add_u32 s75, s75, s27
    s_waitcnt lgkmcnt(6)
    buffer_store_dwordx4 v[40:43], v98, s[44:47], s75 offen sc1
    s_add_u32 s75, s75, 16384
    s_lshl_b32 s72, s3, 2
    s_add_u32 s72, s72, 163584
    v_mov_b32 v124, s72
    ds_write_b32 v124, v124
    s_waitcnt lgkmcnt(4)
    buffer_store_dwordx4 v[44:47], v126, s[44:47], s26 offen sc1
    s_add_u32 s26, s26, 4096
    s_waitcnt lgkmcnt(2)
    buffer_store_dwordx4 v[48:51], v126, s[44:47], s26 offen sc1
    s_add_u32 s26, s26, 4096
    s_add_u32 s26, s26, s27
    s_waitcnt lgkmcnt(0)
    buffer_store_dwordx4 v[52:55], v126, s[44:47], s26 offen sc1
    s_add_u32 s26, s26, 4096
    s_setprio 0
    v_lshrrev_b32 v1, 5, v127
    v_lshlrev_b32 v2, 3, v1
    v_bfe_u32 v3, v127, 2, 2
    v_add_u32 v2, v2, v3
    v_mul_u32_u24 v2, 192, v2
    v_bfe_u32 v3, v127, 4, 1
    v_lshl_add_u32 v2, v3, 5, v2
    v_and_b32 v6, 3, v127
    v_lshl_add_u32 v102, v6, 3, v2
    v_add_u32 v103, 61440, v102
    s_lshl_b32 s7, s4, 2
    s_add_u32 s7, s7, s3
    s_mul_i32 s7, s7, 40960
    v_add_u32 v104, s7, v126
    s_lshl_b32 s74, s77, 10
    v_mul_u32_u24 v2, 49152, v3
    v_lshl_add_u32 v2, v1, 8, v2
    v_and_b32 v3, 15, v127
    v_lshl_add_u32 v105, v3, 4, v2
    s_lshl_b32 s76, s4, 3
    s_lshl_b32 s7, s3, 1
    s_add_u32 s76, s76, s7
    s_mul_i32 s76, s76, 49152
    s_mul_i32 s7, s5, 3072
    s_add_u32 s76, s76, s7
    s_add_u32 s76, s76, 7340032
    v_bfe_u32 v107, v127, 1, 4
    s_mul_i32 s7, s5, 192
    v_lshl_add_u32 v107, v107, 2, s7
    v_and_b32 v108, 1, v127
    v_lshlrev_b32 v108, 4, v108
    s_lshl_b32 s7, s4, 11
    s_add_u32 s7, s7, 16252928
    v_lshl_add_u32 v109, v3, 7, s7
    s_cmp_lg_u32 s3, 0
    s_cbranch_scc1 L_ep_w
    s_waitcnt vmcnt(6)
    s_mov_b32 s73, 0
L_ep:
    v_readfirstlane_b32 s60, v101
    s_nop 1
    s_cmp_lg_u32 s60, 0
    s_cbranch_scc1 L_ep_ok
    s_add_u32 s73, s73, 1
    s_cmp_ge_u32 s73, 50000
    s_cbranch_scc1 L_ep_to
    s_sleep 4
    s_mov_b64 exec, 1
    global_load_dword v101, v126, s[38:39] sc1
    s_mov_b64 exec, -1
    s_waitcnt vmcnt(0)
    s_branch L_ep
L_ep_to:
    s_mov_b32 s60, 1
L_ep_ok:
    v_mov_b32 v124, 163328
    v_mov_b32 v125, s60
    ds_write_b32 v124, v125
    s_branch L_ep_done
L_ep_w:
    v_mov_b32 v124, 163328
    s_mov_b32 s73, 0
L_lw2:
    ds_read_b32 v125, v124
    s_add_u32 s73, s73, 1
    s_waitcnt lgkmcnt(0)
    v_cmp_eq_u32 vcc, 0, v125
    s_nop 1
    s_cbranch_vccz L_lw2_ok
    s_sleep 1
    s_cmp_lt_u32 s73, 3200000
    s_cbranch_scc1 L_lw2
L_lw2_ok:
    v_readfirstlane_b32 s60, v125
L_ep_done:
    s_waitcnt vmcnt(3)
    s_nop 0
    v_mov_b32 v124, s60
    s_mov_b64 exec, 1
    buffer_store_dword v124, v126, s[44:47], s79 offen sc1
    s_mov_b64 exec, -1
    global_load_dword v48, v107, s[30:31] offset:0
    global_load_dword v52, v107, s[30:31] offset:64
    global_load_dword v56, v107, s[30:31] offset:128
    s_add_u32 s10, s51, 0
    s_sub_u32 s7, s10, 12
    s_cmp_ge_u32 s10, 12
    s_cselect_b32 s10, s7, s10
    s_sub_u32 s7, s10, 12
    s_cmp_ge_u32 s10, 12
    s_cselect_b32 s10, s7, s10
    s_lshl_b32 s10, s10, 10
    s_add_u32 s11, s10, 1024
    s_cmp_ge_u32 s11, 12288
    s_cselect_b32 s11, 0, s11
    s_add_u32 s12, s11, 1024
    s_cmp_ge_u32 s12, 12288
    s_cselect_b32 s12, 0, s12
    s_add_u32 s13, s12, 1024
    s_cmp_ge_u32 s13, 12288
    s_cselect_b32 s13, 0, s13
    s_add_u32 s14, s13, 1024
    s_cmp_ge_u32 s14, 12288
    s_cselect_b32 s14, 0, s14
    s_add_u32 s15, s14, 1024
    s_cmp_ge_u32 s15, 12288
    s_cselect_b32 s15, 0, s15
    s_mul_i32 s71, s63, 240
    s_mul_i32 s7, s3, 12
    s_add_u32 s71, s71, s7
    s_lshl_b32 s71, s71, 10
    s_add_u32 s71, s71, 5242880
    v_add_u32 v106, s71, v126
    s_mul_i32 s71, s3, 12288
    s_add_u32 s71, s71, 7340032
    s_add_u32 s16, s3, 1
    s_and_b32 s16, s16, 3
    s_lshl_b32 s70, s62, 2
    s_add_u32 s70, s70, s16
    s_mul_i32 s70, s70, 49152
    s_add_u32 s22, s70, s71
    s_add_u32 s17, s3, 2
    s_and_b32 s17, s17, 3
    s_lshl_b32 s70, s62, 2
    s_add_u32 s70, s70, s17
    s_mul_i32 s70, s70, 49152
    s_add_u32 s23, s70, s71
    s_add_u32 s18, s3, 3
    s_and_b32 s18, s18, 3
    s_lshl_b32 s70, s62, 2
    s_add_u32 s70, s70, s18
    s_mul_i32 s70, s70, 49152
    s_add_u32 s24, s70, s71
    s_add_u32 s19, s3, 4
    s_and_b32 s19, s19, 3
    s_lshl_b32 s70, s62, 2
    s_add_u32 s70, s70, s19
    s_mul_i32 s70, s70, 49152
    s_add_u32 s25, s70, s71
    s_lshl_b32 s7, s4, 6
    s_lshl_b32 s71, s3, 4
    s_add_u32 s7, s7, s71
    s_add_u32 s7, s7, s5
    s_lshr_b32 s71, s7, 2
    s_lshl_b32 s71, s71, 7
    s_and_b32 s79, s7, 3
    s_lshl_b32 s79, s79, 2
    s_add_u32 s79, s79, s71
    s_add_u32 s79, s79, 16293888
    v_cmp_gt_u32 vcc, 32, v127
    v_mov_b32 v60, 0x3f80
    s_nop 0
    v_cndmask_b32 v60, 0, v60, vcc
    v_mov_b32 v61, 0
    v_mov_b32 v62, 0
    v_mov_b32 v63, 0
    s_cmp_lg_u32 s3, 0
    s_cbranch_scc1 L_p0skip
    v_mov_b32 v124, 163352
    s_mov_b32 s73, 0
L_lw3:
    ds_read_b32 v125, v124
    s_add_u32 s73, s73, 1
    s_waitcnt lgkmcnt(0)
    v_cmp_eq_u32 vcc, 0, v125
    s_nop 1
    s_cbranch_vccz L_lw3_ok
    s_sleep 1
    s_cmp_lt_u32 s73, 3200000
    s_cbranch_scc1 L_lw3
L_lw3_ok:
    buffer_load_dwordx4 v[120:123], v109, s[44:47], 0 offen sc1
L_p0skip:
    s_waitcnt vmcnt(0)
    s_lshl_b32 s72, s3, 2
    s_add_u32 s72, s72, 163440
    v_mov_b32 v124, s72
    ds_write_b32 v124, v124
    s_cmp_lg_u32 s3, 3
    s_cbranch_scc1 L_nofa
    v_and_b32 v124, 3, v127
    v_lshlrev_b32 v124, 2, v124
    v_add_u32 v124, 163440, v124
    s_mov_b32 s73, 0
L_lw4:
    ds_read_b32 v125, v124
    s_add_u32 s73, s73, 1
    s_waitcnt lgkmcnt(0)
    v_cmp_eq_u32 vcc, 0, v125
    s_nop 1
    s_cbranch_vccz L_lw4_ok
    s_sleep 1
    s_cmp_lt_u32 s73, 3200000
    s_cbranch_scc1 L_lw4
L_lw4_ok:
    s_lshr_b32 s70, s6, 2
    s_lshl_b32 s70, s70, 7
    s_and_b32 s7, s6, 3
    s_lshl_b32 s7, s7, 2
    s_add_u32 s7, s7, s70
    s_add_u32 s7, s7, 16285696
    v_mov_b32 v124, s60
    s_mov_b64 exec, 1
    buffer_store_dword v124, v126, s[44:47], s7 offen sc1
    s_mov_b64 exec, -1
L_nofa:
    s_cmp_lg_u32 s3, 0
    s_cbranch_scc1 L_gate5_w
    s_mov_b32 s73, 0
    s_branch L_poll6_c
L_poll6:
    buffer_load_dwordx4 v[120:123], v109, s[44:47], 0 offen sc1
    s_waitcnt vmcnt(0)
L_poll6_c:
    v_xor_b32 v120, s60, v120
    v_xor_b32 v121, s60, v121
    v_xor_b32 v122, s60, v122
    v_xor_b32 v123, s60, v123
    v_or_b32 v120, v120, v121
    v_or3_b32 v120, v120, v122, v123
    v_cmp_ne_u32 vcc, 0, v120
    s_nop 1
    s_cbranch_vccz L_poll6_ok
    s_add_u32 s73, s73, 1
    s_sleep 4
    s_cmp_lt_u32 s73, 50000
    s_cbranch_scc1 L_poll6
L_poll6_ok:
    v_mov_b32 v124, 163336
    ds_write_b32 v124, v124
    s_branch L_gate5_ok
L_gate5_w:
    v_mov_b32 v124, 163336
    s_mov_b32 s73, 0
L_lw7:
    ds_read_b32 v125, v124
    s_add_u32 s73, s73, 1
    s_waitcnt lgkmcnt(0)
    v_cmp_eq_u32 vcc, 0, v125
    s_nop 1
    s_cbranch_vccz L_lw7_ok
    s_sleep 1
    s_cmp_lt_u32 s73, 3200000
    s_cbranch_scc1 L_lw7
L_lw7_ok:
L_gate5_ok:
    buffer_load_dwordx4 a[0:3], v104, s[44:47], s74 offen offset:0 sc1
    buffer_load_dwordx4 a[4:7], v104, s[44:47], s74 offen offset:1024 sc1
    buffer_load_dwordx4 a[8:11], v104, s[44:47], s74 offen offset:2048 sc1
    buffer_load_dwordx4 a[12:15], v104, s[44:47], s74 offen offset:3072 sc1
    s_add_u32 s74, s74, 4096
    s_cmp_ge_u32 s74, 40960
    s_cselect_b32 s74, 0, s74
    buffer_load_dwordx4 a[16:19], v104, s[44:47], s74 offen offset:0 sc1
    buffer_load_dwordx4 a[20:23], v104, s[44:47], s74 offen offset:1024 sc1
    buffer_load_dwordx4 a[24:27], v104, s[44:47], s74 offen offset:2048 sc1
    buffer_load_dwordx4 a[28:31], v104, s[44:47], s74 offen offset:3072 sc1
    s_add_u32 s74, s74, 4096
    s_cmp_ge_u32 s74, 40960
    s_cselect_b32 s74, 0, s74
    buffer_load_dwordx4 a[32:35], v104, s[44:47], s74 offen offset:0 sc1
    buffer_load_dwordx4 a[36:39], v104, s[44:47], s74 offen offset:1024 sc1
    buffer_load_dwordx4 a[40:43], v104, s[44:47], s74 offen offset:2048 sc1
    buffer_load_dwordx4 a[44:47], v104, s[44:47], s74 offen offset:3072 sc1
    s_add_u32 s74, s74, 4096
    s_cmp_ge_u32 s74, 40960
    s_cselect_b32 s74, 0, s74
    buffer_load_dwordx4 a[48:51], v104, s[44:47], s74 offen offset:0 sc1
    buffer_load_dwordx4 a[52:55], v104, s[44:47], s74 offen offset:1024 sc1
    v_lshrrev_b32 v48, v108, v48
    v_mov_b32 v49, 0
    v_mov_b32 v50, 0
    v_mov_b32 v51, 0
    v_lshrrev_b32 v52, v108, v52
    v_mov_b32 v53, 0
    v_mov_b32 v54, 0
    v_mov_b32 v55, 0
    v_lshrrev_b32 v56, v108, v56
    v_mov_b32 v57, 0
    v_mov_b32 v58, 0
    v_mov_b32 v59, 0
    v_mfma_f32_32x32x16_bf16 v[0:15], v[48:51], v[60:63], 0
    v_mfma_f32_32x32x16_bf16 v[16:31], v[52:55], v[60:63], 0
    v_mfma_f32_32x32x16_bf16 v[32:47], v[56:59], v[60:63], 0
    v_mov_b32 v124, 163520
    s_mov_b32 s73, 0
L_lw8:
    ds_read_b32 v125, v124
    s_add_u32 s73, s73, 1
    s_waitcnt lgkmcnt(0)
    v_cmp_eq_u32 vcc, 0, v125
    s_nop 1
    s_cbranch_vccz L_lw8_ok
    s_sleep 1
    s_cmp_lt_u32 s73, 3200000
    s_cbranch_scc1 L_lw8
L_lw8_ok:
    s_lshl_b32 s72, s3, 2
    s_add_u32 s72, s72, 163536
    v_mov_b32 v124, s72
    s_mov_b32 s73, 0
L_lw9:
    ds_read_b32 v125, v124
    s_add_u32 s73, s73, 1
    s_waitcnt lgkmcnt(0)
    v_cmp_eq_u32 vcc, 0, v125
    s_nop 1
    s_cbranch_vccz L_lw9_ok
    s_sleep 1
    s_cmp_lt_u32 s73, 3200000
    s_cbranch_scc1 L_lw9
L_lw9_ok:
    s_setprio 1
    ds_read_b64_tr_b16 a[64:65], v102 offset:0
    ds_read_b64_tr_b16 a[66:67], v102 offset:768
    ds_read_b64_tr_b16 a[68:69], v102 offset:64
    ds_read_b64_tr_b16 a[70:71], v102 offset:832
    ds_read_b64_tr_b16 a[72:73], v102 offset:128
    ds_read_b64_tr_b16 a[74:75], v102 offset:896
    ds_read_b64_tr_b16 a[76:77], v102 offset:3072
    ds_read_b64_tr_b16 a[78:79], v102 offset:3840
    ds_read_b64_tr_b16 a[80:81], v102 offset:3136
    ds_read_b64_tr_b16 a[82:83], v102 offset:3904
    ds_read_b64_tr_b16 a[84:85], v102 offset:3200
    ds_read_b64_tr_b16 a[86:87], v102 offset:3968
    s_waitcnt vmcnt(13) lgkmcnt(6)
    v_mfma_f32_32x32x16_bf16 v[0:15], a[64:67], a[0:3], v[0:15]
    ds_read_b64_tr_b16 a[88:89], v102 offset:6144
    ds_read_b64_tr_b16 a[90:91], v102 offset:6912
    v_mfma_f32_32x32x16_bf16 v[16:31], a[68:71], a[0:3], v[16:31]
    ds_read_b64_tr_b16 a[92:93], v102 offset:6208
    ds_read_b64_tr_b16 a[94:95], v102 offset:6976
    buffer_load_dwordx4 a[56:59], v104, s[44:47], s74 offen offset:2048 sc1
    v_mfma_f32_32x32x16_bf16 v[32:47], a[72:75], a[0:3], v[32:47]
    ds_read_b64_tr_b16 a[96:97], v102 offset:6272
    ds_read_b64_tr_b16 a[98:99], v102 offset:7040
    s_waitcnt vmcnt(13) lgkmcnt(6)
    v_mfma_f32_32x32x16_bf16 v[0:15], a[76:79], a[4:7], v[0:15]
    ds_read_b64_tr_b16 a[64:65], v102 offset:9216
    ds_read_b64_tr_b16 a[66:67], v102 offset:9984
    v_mfma_f32_32x32x16_bf16 v[16:31], a[80:83], a[4:7], v[16:31]
    ds_read_b64_tr_b16 a[68:69], v102 offset:9280
    ds_read_b64_tr_b16 a[70:71], v102 offset:10048
    buffer_load_dwordx4 a[60:63], v104, s[44:47], s74 offen offset:3072 sc1
    v_mfma_f32_32x32x16_bf16 v[32:47], a[84:87], a[4:7], v[32:47]
    ds_read_b64_tr_b16 a[72:73], v102 offset:9344
    ds_read_b64_tr_b16 a[74:75], v102 offset:10112
    s_waitcnt vmcnt(13) lgkmcnt(6)
    v_mfma_f32_32x32x16_bf16 v[0:15], a[88:91], a[8:11], v[0:15]
    ds_read_b64_tr_b16 a[76:77], v102 offset:12288
    ds_read_b64_tr_b16 a[78:79], v102 offset:13056
    v_mfma_f32_32x32x16_bf16 v[16:31], a[92:95], a[8:11], v[16:31]
    ds_read_b64_tr_b16 a[80:81], v102 offset:12352
    ds_read_b64_tr_b16 a[82:83], v102 offset:13120
    s_add_u32 s74, s74, 4096
    s_cmp_ge_u32 s74, 40960
    s_cselect_b32 s74, 0, s74
    buffer_load_dwordx4 a[0:3], v104, s[44:47], s74 offen offset:0 sc1
    v_mfma_f32_32x32x16_bf16 v[32:47], a[96:99], a[8:11], v[32:47]
    ds_read_b64_tr_b16 a[84:85], v102 offset:12416
    ds_read_b64_tr_b16 a[86:87], v102 offset:13184
    s_waitcnt vmcnt(13) lgkmcnt(6)
    v_mfma_f32_32x32x16_bf16 v[0:15], a[64:67], a[12:15], v[0:15]
    ds_read_b64_tr_b16 a[88:89], v102 offset:15360
    ds_read_b64_tr_b16 a[90:91], v102 offset:16128
    v_mfma_f32_32x32x16_bf16 v[16:31], a[68:71], a[12:15], v[16:31]
    ds_read_b64_tr_b16 a[92:93], v102 offset:15424
    ds_read_b64_tr_b16 a[94:95], v102 offset:16192
    buffer_load_dwordx4 a[4:7], v104, s[44:47], s74 offen offset:1024 sc1
    v_mfma_f32_32x32x16_bf16 v[32:47], a[72:75], a[12:15], v[32:47]
    ds_read_b64_tr_b16 a[96:97], v102 offset:15488
    ds_read_b64_tr_b16 a[98:99], v102 offset:16256
    s_waitcnt vmcnt(13) lgkmcnt(6)
    v_mfma_f32_32x32x16_bf16 v[0:15], a[76:79], a[16:19], v[0:15]
    ds_read_b64_tr_b16 a[64:65], v102 offset:18432
    ds_read_b64_tr_b16 a[66:67], v102 offset:19200
    v_mfma_f32_32x32x16_bf16 v[16:31], a[80:83], a[16:19], v[16:31]
    ds_read_b64_tr_b16 a[68:69], v102 offset:18496
    ds_read_b64_tr_b16 a[70:71], v102 offset:19264
    buffer_load_dwordx4 a[8:11], v104, s[44:47], s74 offen offset:2048 sc1
    v_mfma_f32_32x32x16_bf16 v[32:47], a[84:87], a[16:19], v[32:47]
    ds_read_b64_tr_b16 a[72:73], v102 offset:18560
    ds_read_b64_tr_b16 a[74:75], v102 offset:19328
    s_waitcnt vmcnt(13) lgkmcnt(6)
    v_mfma_f32_32x32x16_bf16 v[0:15], a[88:91], a[20:23], v[0:15]
    ds_read_b64_tr_b16 a[76:77], v102 offset:21504
    ds_read_b64_tr_b16 a[78:79], v102 offset:22272
    v_mfma_f32_32x32x16_bf16 v[16:31], a[92:95], a[20:23], v[16:31]
    ds_read_b64_tr_b16 a[80:81], v102 offset:21568
    ds_read_b64_tr_b16 a[82:83], v102 offset:22336
    buffer_load_dwordx4 a[12:15], v104, s[44:47], s74 offen offset:3072 sc1
    v_mfma_f32_32x32x16_bf16 v[32:47], a[96:99], a[20:23], v[32:47]
    ds_read_b64_tr_b16 a[84:85], v102 offset:21632
    ds_read_b64_tr_b16 a[86:87], v102 offset:22400
    s_waitcnt vmcnt(13) lgkmcnt(6)
    v_mfma_f32_32x32x16_bf16 v[0:15], a[64:67], a[24:27], v[0:15]
    ds_read_b64_tr_b16 a[88:89], v102 offset:24576
    ds_read_b64_tr_b16 a[90:91], v102 offset:25344
    v_mfma_f32_32x32x16_bf16 v[16:31], a[68:71], a[24:27], v[16:31]
    ds_read_b64_tr_b16 a[92:93], v102 offset:24640
    ds_read_b64_tr_b16 a[94:95], v102 offset:25408
    s_add_u32 s74, s74, 4096
    s_cmp_ge_u32 s74, 40960
    s_cselect_b32 s74, 0, s74
    buffer_load_dwordx4 a[16:19], v104, s[44:47], s74 offen offset:0 sc1
    v_mfma_f32_32x32x16_bf16 v[32:47], a[72:75], a[24:27], v[32:47]
    ds_read_b64_tr_b16 a[96:97], v102 offset:24704
    ds_read_b64_tr_b16 a[98:99], v102 offset:25472
    s_waitcnt vmcnt(13) lgkmcnt(6)
    v_mfma_f32_32x32x16_bf16 v[0:15], a[76:79], a[28:31], v[0:15]
    ds_read_b64_tr_b16 a[64:65], v102 offset:27648
    ds_read_b64_tr_b16 a[66:67], v102 offset:28416
    v_mfma_f32_32x32x16_bf16 v[16:31], a[80:83], a[28:31], v[16:31]
    ds_read_b64_tr_b16 a[68:69], v102 offset:27712
    ds_read_b64_tr_b16 a[70:71], v102 offset:28480
    buffer_load_dwordx4 a[20:23], v104, s[44:47], s74 offen offset:1024 sc1
    v_mfma_f32_32x32x16_bf16 v[32:47], a[84:87], a[28:31], v[32:47]
    ds_read_b64_tr_b16 a[72:73], v102 offset:27776
    ds_read_b64_tr_b16 a[74:75], v102 offset:28544
    v_mov_b32 v124, 163524
    s_mov_b32 s73, 0
L_lw10:
    ds_read_b32 v125, v124
    s_add_u32 s73, s73, 1
    s_waitcnt lgkmcnt(0)
    v_cmp_eq_u32 vcc, 0, v125
    s_nop 1
    s_cbranch_vccz L_lw10_ok
    s_sleep 1
    s_cmp_lt_u32 s73, 3200000
    s_cbranch_scc1 L_lw10
L_lw10_ok:
    s_waitcnt vmcnt(13) lgkmcnt(6)
    v_mfma_f32_32x32x16_bf16 v[0:15], a[88:91], a[32:35], v[0:15]
    ds_read_b64_tr_b16 a[76:77], v102 offset:30720
    ds_read_b64_tr_b16 a[78:79], v102 offset:31488
    v_mfma_f32_32x32x16_bf16 v[16:31], a[92:95], a[32:35], v[16:31]
    ds_read_b64_tr_b16 a[80:81], v102 offset:30784
    ds_read_b64_tr_b16 a[82:83], v102 offset:31552
    buffer_load_dwordx4 a[24:27], v104, s[44:47], s74 offen offset:2048 sc1
    v_mfma_f32_32x32x16_bf16 v[32:47], a[96:99], a[32:35], v[32:47]
    ds_read_b64_tr_b16 a[84:85], v102 offset:30848
    ds_read_b64_tr_b16 a[86:87], v102 offset:31616
    s_waitcnt vmcnt(13) lgkmcnt(6)
    v_mfma_f32_32x32x16_bf16 v[0:15], a[64:67], a[36:39], v[0:15]
    ds_read_b64_tr_b16 a[88:89], v102 offset:33792
    ds_read_b64_tr_b16 a[90:91], v102 offset:34560
    v_mfma_f32_32x32x16_bf16 v[16:31], a[68:71], a[36:39], v[16:31]
    ds_read_b64_tr_b16 a[92:93], v102 offset:33856
    ds_read_b64_tr_b16 a[94:95], v102 offset:34624
    buffer_load_dwordx4 a[28:31], v104, s[44:47], s74 offen offset:3072 sc1
    v_mfma_f32_32x32x16_bf16 v[32:47], a[72:75], a[36:39], v[32:47]
    ds_read_b64_tr_b16 a[96:97], v102 offset:33920
    ds_read_b64_tr_b16 a[98:99], v102 offset:34688
    s_waitcnt vmcnt(13) lgkmcnt(6)
    v_mfma_f32_32x32x16_bf16 v[0:15], a[76:79], a[40:43], v[0:15]
    ds_read_b64_tr_b16 a[64:65], v102 offset:36864
    ds_read_b64_tr_b16 a[66:67], v102 offset:37632
    v_mfma_f32_32x32x16_bf16 v[16:31], a[80:83], a[40:43], v[16:31]
    ds_read_b64_tr_b16 a[68:69], v102 offset:36928
    ds_read_b64_tr_b16 a[70:71], v102 offset:37696
    s_add_u32 s74, s74, 4096
    s_cmp_ge_u32 s74, 40960
    s_cselect_b32 s74, 0, s74
    buffer_load_dwordx4 a[32:35], v104, s[44:47], s74 offen offset:0 sc1
    v_mfma_f32_32x32x16_bf16 v[32:47], a[84:87], a[40:43], v[32:47]
    ds_read_b64_tr_b16 a[72:73], v102 offset:36992
    ds_read_b64_tr_b16 a[74:75], v102 offset:37760
    s_waitcnt vmcnt(13) lgkmcnt(6)
    v_mfma_f32_32x32x16_bf16 v[0:15], a[88:91], a[44:47], v[0:15]
    ds_read_b64_tr_b16 a[76:77], v102 offset:39936
    ds_read_b64_tr_b16 a[78:79], v102 offset:40704
    v_mfma_f32_32x32x16_bf16 v[16:31], a[92:95], a[44:47], v[16:31]
    ds_read_b64_tr_b16 a[80:81], v102 offset:40000
    ds_read_b64_tr_b16 a[82:83], v102 offset:40768
    buffer_load_dwordx4 a[36:39], v104, s[44:47], s74 offen offset:1024 sc1
    v_mfma_f32_32x32x16_bf16 v[32:47], a[96:99], a[44:47], v[32:47]
    ds_read_b64_tr_b16 a[84:85], v102 offset:40064
    ds_read_b64_tr_b16 a[86:87], v102 offset:40832
    s_waitcnt vmcnt(13) lgkmcnt(6)
    v_mfma_f32_32x32x16_bf16 v[0:15], a[64:67], a[48:51], v[0:15]
    ds_read_b64_tr_b16 a[88:89], v102 offset:43008
    ds_read_b64_tr_b16 a[90:91], v102 offset:43776
    v_mfma_f32_32x32x16_bf16 v[16:31], a[68:71], a[48:51], v[16:31]
    ds_read_b64_tr_b16 a[92:93], v102 offset:43072
    ds_read_b64_tr_b16 a[94:95], v102 offset:43840
    buffer_load_dwordx4 a[40:43], v104, s[44:47], s74 offen offset:2048 sc1
    v_mfma_f32_32x32x16_bf16 v[32:47], a[72:75], a[48:51], v[32:47]
    ds_read_b64_tr_b16 a[96:97], v102 offset:43136
    ds_read_b64_tr_b16 a[98:99], v102 offset:43904
    s_waitcnt vmcnt(13) lgkmcnt(6)
    v_mfma_f32_32x32x16_bf16 v[0:15], a[76:79], a[52:55], v[0:15]
    ds_read_b64_tr_b16 a[64:65], v102 offset:46080
    ds_read_b64_tr_b16 a[66:67], v102 offset:46848
    v_mfma_f32_32x32x16_bf16 v[16:31], a[80:83], a[52:55], v[16:31]
    ds_read_b64_tr_b16 a[68:69], v102 offset:46144
    ds_read_b64_tr_b16 a[70:71], v102 offset:46912
    buffer_load_dwordx4 a[44:47], v104, s[44:47], s74 offen offset:3072 sc1
    v_mfma_f32_32x32x16_bf16 v[32:47], a[84:87], a[52:55], v[32:47]
    ds_read_b64_tr_b16 a[72:73], v102 offset:46208
    ds_read_b64_tr_b16 a[74:75], v102 offset:46976
    s_waitcnt vmcnt(13) lgkmcnt(6)
    v_mfma_f32_32x32x16_bf16 v[0:15], a[88:91], a[56:59], v[0:15]
    ds_read_b64_tr_b16 a[76:77], v102 offset:49152
    ds_read_b64_tr_b16 a[78:79], v102 offset:49920
    v_mfma_f32_32x32x16_bf16 v[16:31], a[92:95], a[56:59], v[16:31]
    ds_read_b64_tr_b16 a[80:81], v102 offset:49216
    ds_read_b64_tr_b16 a[82:83], v102 offset:49984
    s_add_u32 s74, s74, 4096
    s_cmp_ge_u32 s74, 40960
    s_cselect_b32 s74, 0, s74
    buffer_load_dwordx4 a[48:51], v104, s[44:47], s74 offen offset:0 sc1
    v_mfma_f32_32x32x16_bf16 v[32:47], a[96:99], a[56:59], v[32:47]
    ds_read_b64_tr_b16 a[84:85], v102 offset:49280
    ds_read_b64_tr_b16 a[86:87], v102 offset:50048
    s_waitcnt vmcnt(13) lgkmcnt(6)
    v_mfma_f32_32x32x16_bf16 v[0:15], a[64:67], a[60:63], v[0:15]
    ds_read_b64_tr_b16 a[88:89], v102 offset:52224
    ds_read_b64_tr_b16 a[90:91], v102 offset:52992
    v_mfma_f32_32x32x16_bf16 v[16:31], a[68:71], a[60:63], v[16:31]
    ds_read_b64_tr_b16 a[92:93], v102 offset:52288
    ds_read_b64_tr_b16 a[94:95], v102 offset:53056
    buffer_load_dwordx4 a[52:55], v104, s[44:47], s74 offen offset:1024 sc1
    v_mfma_f32_32x32x16_bf16 v[32:47], a[72:75], a[60:63], v[32:47]
    ds_read_b64_tr_b16 a[96:97], v102 offset:52352
    ds_read_b64_tr_b16 a[98:99], v102 offset:53120
    s_waitcnt vmcnt(13) lgkmcnt(6)
    v_mfma_f32_32x32x16_bf16 v[0:15], a[76:79], a[0:3], v[0:15]
    ds_read_b64_tr_b16 a[64:65], v102 offset:55296
    ds_read_b64_tr_b16 a[66:67], v102 offset:56064
    v_mfma_f32_32x32x16_bf16 v[16:31], a[80:83], a[0:3], v[16:31]
    ds_read_b64_tr_b16 a[68:69], v102 offset:55360
    ds_read_b64_tr_b16 a[70:71], v102 offset:56128
    buffer_load_dwordx4 a[56:59], v104, s[44:47], s74 offen offset:2048 sc1
    v_mfma_f32_32x32x16_bf16 v[32:47], a[84:87], a[0:3], v[32:47]
    ds_read_b64_tr_b16 a[72:73], v102 offset:55424
    ds_read_b64_tr_b16 a[74:75], v102 offset:56192
    s_waitcnt vmcnt(13) lgkmcnt(6)
    v_mfma_f32_32x32x16_bf16 v[0:15], a[88:91], a[4:7], v[0:15]
    ds_read_b64_tr_b16 a[76:77], v102 offset:58368
    ds_read_b64_tr_b16 a[78:79], v102 offset:59136
    v_mfma_f32_32x32x16_bf16 v[16:31], a[92:95], a[4:7], v[16:31]
    ds_read_b64_tr_b16 a[80:81], v102 offset:58432
    ds_read_b64_tr_b16 a[82:83], v102 offset:59200
    buffer_load_dwordx4 a[60:63], v104, s[44:47], s74 offen offset:3072 sc1
    v_mfma_f32_32x32x16_bf16 v[32:47], a[96:99], a[4:7], v[32:47]
    ds_read_b64_tr_b16 a[84:85], v102 offset:58496
    ds_read_b64_tr_b16 a[86:87], v102 offset:59264
    v_mov_b32 v124, 163528
    s_mov_b32 s73, 0
L_lw11:
    ds_read_b32 v125, v124
    s_add_u32 s73, s73, 1
    s_waitcnt lgkmcnt(0)
    v_cmp_eq_u32 vcc, 0, v125
    s_nop 1
    s_cbranch_vccz L_lw11_ok
    s_sleep 1
    s_cmp_lt_u32 s73, 3200000
    s_cbranch_scc1 L_lw11
L_lw11_ok:
    s_waitcnt vmcnt(13) lgkmcnt(6)
    v_mfma_f32_32x32x16_bf16 v[0:15], a[64:67], a[8:11], v[0:15]
    ds_read_b64_tr_b16 a[88:89], v103 offset:0
    ds_read_b64_tr_b16 a[90:91], v103 offset:768
    v_mfma_f32_32x32x16_bf16 v[16:31], a[68:71], a[8:11], v[16:31]
    ds_read_b64_tr_b16 a[92:93], v103 offset:64
    ds_read_b64_tr_b16 a[94:95], v103 offset:832
    s_add_u32 s74, s74, 4096
    s_cmp_ge_u32 s74, 40960
    s_cselect_b32 s74, 0, s74
    buffer_load_dwordx4 a[0:3], v104, s[44:47], s74 offen offset:0 sc1
    v_mfma_f32_32x32x16_bf16 v[32:47], a[72:75], a[8:11], v[32:47]
    ds_read_b64_tr_b16 a[96:97], v103 offset:128
    ds_read_b64_tr_b16 a[98:99], v103 offset:896
    s_waitcnt vmcnt(13) lgkmcnt(6)
    v_mfma_f32_32x32x16_bf16 v[0:15], a[76:79], a[12:15], v[0:15]
    ds_read_b64_tr_b16 a[64:65], v103 offset:3072
    ds_read_b64_tr_b16 a[66:67], v103 offset:3840
    v_mfma_f32_32x32x16_bf16 v[16:31], a[80:83], a[12:15], v[16:31]
    ds_read_b64_tr_b16 a[68:69], v103 offset:3136
    ds_read_b64_tr_b16 a[70:71], v103 offset:3904
    buffer_load_dwordx4 a[4:7], v104, s[44:47], s74 offen offset:1024 sc1
    v_mfma_f32_32x32x16_bf16 v[32:47], a[84:87], a[12:15], v[32:47]
    ds_read_b64_tr_b16 a[72:73], v103 offset:3200
    ds_read_b64_tr_b16 a[74:75], v103 offset:3968
    s_waitcnt vmcnt(13) lgkmcnt(6)
    v_mfma_f32_32x32x16_bf16 v[0:15], a[88:91], a[16:19], v[0:15]
    ds_read_b64_tr_b16 a[76:77], v103 offset:6144
    ds_read_b64_tr_b16 a[78:79], v103 offset:6912
    v_mfma_f32_32x32x16_bf16 v[16:31], a[92:95], a[16:19], v[16:31]
    ds_read_b64_tr_b16 a[80:81], v103 offset:6208
    ds_read_b64_tr_b16 a[82:83], v103 offset:6976
    buffer_load_dwordx4 a[8:11], v104, s[44:47], s74 offen offset:2048 sc1
    v_mfma_f32_32x32x16_bf16 v[32:47], a[96:99], a[16:19], v[32:47]
    ds_read_b64_tr_b16 a[84:85], v103 offset:6272
    ds_read_b64_tr_b16 a[86:87], v103 offset:7040
    s_waitcnt vmcnt(13) lgkmcnt(6)
    v_mfma_f32_32x32x16_bf16 v[0:15], a[64:67], a[20:23], v[0:15]
    ds_read_b64_tr_b16 a[88:89], v103 offset:9216
    ds_read_b64_tr_b16 a[90:91], v103 offset:9984
    v_mfma_f32_32x32x16_bf16 v[16:31], a[68:71], a[20:23], v[16:31]
    ds_read_b64_tr_b16 a[92:93], v103 offset:9280
    ds_read_b64_tr_b16 a[94:95], v103 offset:10048
    buffer_load_dwordx4 a[12:15], v104, s[44:47], s74 offen offset:3072 sc1
    v_mfma_f32_32x32x16_bf16 v[32:47], a[72:75], a[20:23], v[32:47]
    ds_read_b64_tr_b16 a[96:97], v103 offset:9344
    ds_read_b64_tr_b16 a[98:99], v103 offset:10112
    s_waitcnt vmcnt(13) lgkmcnt(6)
    v_mfma_f32_32x32x16_bf16 v[0:15], a[76:79], a[24:27], v[0:15]
    ds_read_b64_tr_b16 a[64:65], v103 offset:12288
    ds_read_b64_tr_b16 a[66:67], v103 offset:13056
    v_mfma_f32_32x32x16_bf16 v[16:31], a[80:83], a[24:27], v[16:31]
    ds_read_b64_tr_b16 a[68:69], v103 offset:12352
    ds_read_b64_tr_b16 a[70:71], v103 offset:13120
    s_add_u32 s74, s74, 4096
    s_cmp_ge_u32 s74, 40960
    s_cselect_b32 s74, 0, s74
    buffer_load_dwordx4 a[16:19], v104, s[44:47], s74 offen offset:0 sc1
    v_mfma_f32_32x32x16_bf16 v[32:47], a[84:87], a[24:27], v[32:47]
    ds_read_b64_tr_b16 a[72:73], v103 offset:12416
    ds_read_b64_tr_b16 a[74:75], v103 offset:13184
    s_waitcnt vmcnt(13) lgkmcnt(6)
    v_mfma_f32_32x32x16_bf16 v[0:15], a[88:91], a[28:31], v[0:15]
    ds_read_b64_tr_b16 a[76:77], v103 offset:15360
    ds_read_b64_tr_b16 a[78:79], v103 offset:16128
    v_mfma_f32_32x32x16_bf16 v[16:31], a[92:95], a[28:31], v[16:31]
    ds_read_b64_tr_b16 a[80:81], v103 offset:15424
    ds_read_b64_tr_b16 a[82:83], v103 offset:16192
    buffer_load_dwordx4 a[20:23], v104, s[44:47], s74 offen offset:1024 sc1
    v_mfma_f32_32x32x16_bf16 v[32:47], a[96:99], a[28:31], v[32:47]
    ds_read_b64_tr_b16 a[84:85], v103 offset:15488
    ds_read_b64_tr_b16 a[86:87], v103 offset:16256
    s_waitcnt vmcnt(13) lgkmcnt(6)
    v_mfma_f32_32x32x16_bf16 v[0:15], a[64:67], a[32:35], v[0:15]
    ds_read_b64_tr_b16 a[88:89], v103 offset:18432
    ds_read_b64_tr_b16 a[90:91], v103 offset:19200
    v_mfma_f32_32x32x16_bf16 v[16:31], a[68:71], a[32:35], v[16:31]
    ds_read_b64_tr_b16 a[92:93], v103 offset:18496
    ds_read_b64_tr_b16 a[94:95], v103 offset:19264
    buffer_load_dwordx4 a[24:27], v104, s[44:47], s74 offen offset:2048 sc1
    v_mfma_f32_32x32x16_bf16 v[32:47], a[72:75], a[32:35], v[32:47]
    ds_read_b64_tr_b16 a[96:97], v103 offset:18560
    ds_read_b64_tr_b16 a[98:99], v103 offset:19328
    s_waitcnt vmcnt(13) lgkmcnt(6)
    v_mfma_f32_32x32x16_bf16 v[0:15], a[76:79], a[36:39], v[0:15]
    ds_read_b64_tr_b16 a[64:65], v103 offset:21504
    ds_read_b64_tr_b16 a[66:67], v103 offset:22272
    v_mfma_f32_32x32x16_bf16 v[16:31], a[80:83], a[36:39], v[16:31]
    ds_read_b64_tr_b16 a[68:69], v103 offset:21568
    ds_read_b64_tr_b16 a[70:71], v103 offset:22336
    buffer_load_dwordx4 a[28:31], v104, s[44:47], s74 offen offset:3072 sc1
    v_mfma_f32_32x32x16_bf16 v[32:47], a[84:87], a[36:39], v[32:47]
    ds_read_b64_tr_b16 a[72:73], v103 offset:21632
    ds_read_b64_tr_b16 a[74:75], v103 offset:22400
    s_waitcnt vmcnt(13) lgkmcnt(6)
    v_mfma_f32_32x32x16_bf16 v[0:15], a[88:91], a[40:43], v[0:15]
    ds_read_b64_tr_b16 a[76:77], v103 offset:24576
    ds_read_b64_tr_b16 a[78:79], v103 offset:25344
    v_mfma_f32_32x32x16_bf16 v[16:31], a[92:95], a[40:43], v[16:31]
    ds_read_b64_tr_b16 a[80:81], v103 offset:24640
    ds_read_b64_tr_b16 a[82:83], v103 offset:25408
    v_mfma_f32_32x32x16_bf16 v[32:47], a[96:99], a[40:43], v[32:47]
    ds_read_b64_tr_b16 a[84:85], v103 offset:24704
    ds_read_b64_tr_b16 a[86:87], v103 offset:25472
    s_waitcnt vmcnt(12) lgkmcnt(6)
    v_mfma_f32_32x32x16_bf16 v[0:15], a[64:67], a[44:47], v[0:15]
    ds_read_b64_tr_b16 a[88:89], v103 offset:27648
    ds_read_b64_tr_b16 a[90:91], v103 offset:28416
    v_mfma_f32_32x32x16_bf16 v[16:31], a[68:71], a[44:47], v[16:31]
    ds_read_b64_tr_b16 a[92:93], v103 offset:27712
    ds_read_b64_tr_b16 a[94:95], v103 offset:28480
    v_mfma_f32_32x32x16_bf16 v[32:47], a[72:75], a[44:47], v[32:47]
    ds_read_b64_tr_b16 a[96:97], v103 offset:27776
    ds_read_b64_tr_b16 a[98:99], v103 offset:28544
    v_mov_b32 v124, 163532
    s_mov_b32 s73, 0
L_lw12:
    ds_read_b32 v125, v124
    s_add_u32 s73, s73, 1
    s_waitcnt lgkmcnt(0)
    v_cmp_eq_u32 vcc, 0, v125
    s_nop 1
    s_cbranch_vccz L_lw12_ok
    s_sleep 1
    s_cmp_lt_u32 s73, 3200000
    s_cbranch_scc1 L_lw12
L_lw12_ok:
    s_waitcnt vmcnt(11) lgkmcnt(6)
    v_mfma_f32_32x32x16_bf16 v[0:15], a[76:79], a[48:51], v[0:15]
    ds_read_b64_tr_b16 a[64:65], v103 offset:30720
    ds_read_b64_tr_b16 a[66:67], v103 offset:31488
    v_mfma_f32_32x32x16_bf16 v[16:31], a[80:83], a[48:51], v[16:31]
    ds_read_b64_tr_b16 a[68:69], v103 offset:30784
    ds_read_b64_tr_b16 a[70:71], v103 offset:31552
    v_mfma_f32_32x32x16_bf16 v[32:47], a[84:87], a[48:51], v[32:47]
    ds_read_b64_tr_b16 a[72:73], v103 offset:30848
    ds_read_b64_tr_b16 a[74:75], v103 offset:31616
    s_waitcnt vmcnt(10) lgkmcnt(6)
    v_mfma_f32_32x32x16_bf16 v[0:15], a[88:91], a[52:55], v[0:15]
    ds_read_b64_tr_b16 a[76:77], v103 offset:33792
    ds_read_b64_tr_b16 a[78:79], v103 offset:34560
    v_mfma_f32_32x32x16_bf16 v[16:31], a[92:95], a[52:55], v[16:31]
    ds_read_b64_tr_b16 a[80:81], v103 offset:33856
    ds_read_b64_tr_b16 a[82:83], v103 offset:34624
    v_mfma_f32_32x32x16_bf16 v[32:47], a[96:99], a[52:55], v[32:47]
    ds_read_b64_tr_b16 a[84:85], v103 offset:33920
    ds_read_b64_tr_b16 a[86:87], v103 offset:34688
    s_waitcnt vmcnt(9) lgkmcnt(6)
    v_mfma_f32_32x32x16_bf16 v[0:15], a[64:67], a[56:59], v[0:15]
    ds_read_b64_tr_b16 a[88:89], v103 offset:36864
    ds_read_b64_tr_b16 a[90:91], v103 offset:37632
    v_mfma_f32_32x32x16_bf16 v[16:31], a[68:71], a[56:59], v[16:31]
    ds_read_b64_tr_b16 a[92:93], v103 offset:36928
    ds_read_b64_tr_b16 a[94:95], v103 offset:37696
    v_mfma_f32_32x32x16_bf16 v[32:47], a[72:75], a[56:59], v[32:47]
    ds_read_b64_tr_b16 a[96:97], v103 offset:36992
    ds_read_b64_tr_b16 a[98:99], v103 offset:37760
    s_waitcnt vmcnt(8) lgkmcnt(6)
    v_mfma_f32_32x32x16_bf16 v[0:15], a[76:79], a[60:63], v[0:15]
    ds_read_b64_tr_b16 a[64:65], v103 offset:39936
    ds_read_b64_tr_b16 a[66:67], v103 offset:40704
    v_mfma_f32_32x32x16_bf16 v[16:31], a[80:83], a[60:63], v[16:31]
    ds_read_b64_tr_b16 a[68:69], v103 offset:40000
    ds_read_b64_tr_b16 a[70:71], v103 offset:40768
    v_mfma_f32_32x32x16_bf16 v[32:47], a[84:87], a[60:63], v[32:47]
    ds_read_b64_tr_b16 a[72:73], v103 offset:40064
    ds_read_b64_tr_b16 a[74:75], v103 offset:40832
    s_waitcnt vmcnt(7) lgkmcnt(6)
    v_mfma_f32_32x32x16_bf16 v[0:15], a[88:91], a[0:3], v[0:15]
    ds_read_b64_tr_b16 a[76:77], v103 offset:43008
    ds_read_b64_tr_b16 a[78:79], v103 offset:43776
    v_mfma_f32_32x32x16_bf16 v[16:31], a[92:95], a[0:3], v[16:31]
    ds_read_b64_tr_b16 a[80:81], v103 offset:43072
    ds_read_b64_tr_b16 a[82:83], v103 offset:43840
    v_mfma_f32_32x32x16_bf16 v[32:47], a[96:99], a[0:3], v[32:47]
    ds_read_b64_tr_b16 a[84:85], v103 offset:43136
    ds_read_b64_tr_b16 a[86:87], v103 offset:43904
    s_waitcnt vmcnt(6) lgkmcnt(6)
    v_mfma_f32_32x32x16_bf16 v[0:15], a[64:67], a[4:7], v[0:15]
    ds_read_b64_tr_b16 a[88:89], v103 offset:46080
    ds_read_b64_tr_b16 a[90:91], v103 offset:46848
    v_mfma_f32_32x32x16_bf16 v[16:31], a[68:71], a[4:7], v[16:31]
    ds_read_b64_tr_b16 a[92:93], v103 offset:46144
    ds_read_b64_tr_b16 a[94:95], v103 offset:46912
    v_mfma_f32_32x32x16_bf16 v[32:47], a[72:75], a[4:7], v[32:47]
    ds_read_b64_tr_b16 a[96:97], v103 offset:46208
    ds_read_b64_tr_b16 a[98:99], v103 offset:46976
    s_waitcnt vmcnt(5) lgkmcnt(6)
    v_mfma_f32_32x32x16_bf16 v[0:15], a[76:79], a[8:11], v[0:15]
    ds_read_b64_tr_b16 a[64:65], v103 offset:49152
    ds_read_b64_tr_b16 a[66:67], v103 offset:49920
    v_mfma_f32_32x32x16_bf16 v[16:31], a[80:83], a[8:11], v[16:31]
    ds_read_b64_tr_b16 a[68:69], v103 offset:49216
    ds_read_b64_tr_b16 a[70:71], v103 offset:49984
    v_mfma_f32_32x32x16_bf16 v[32:47], a[84:87], a[8:11], v[32:47]
    ds_read_b64_tr_b16 a[72:73], v103 offset:49280
    ds_read_b64_tr_b16 a[74:75], v103 offset:50048
    v_mov_b32 v48, 0xc0135761
    v_mov_b32 v50, 0xbdd2d3e8
    v_mov_b32 v52, 1.0
    s_lshl_b32 s7, s62, 10
    s_add_u32 s7, s7, 16293888
    v_and_b32 v109, 7, v127
    v_lshl_add_u32 v109, v109, 7, s7
    s_waitcnt vmcnt(4) lgkmcnt(6)
    v_mfma_f32_32x32x16_bf16 v[0:15], a[88:91], a[12:15], v[0:15]
    ds_read_b64_tr_b16 a[76:77], v103 offset:52224
    ds_read_b64_tr_b16 a[78:79], v103 offset:52992
    v_mfma_f32_32x32x16_bf16 v[16:31], a[92:95], a[12:15], v[16:31]
    ds_read_b64_tr_b16 a[80:81], v103 offset:52288
    ds_read_b64_tr_b16 a[82:83], v103 offset:53056
    v_mfma_f32_32x32x16_bf16 v[32:47], a[96:99], a[12:15], v[32:47]
    ds_read_b64_tr_b16 a[84:85], v103 offset:52352
    ds_read_b64_tr_b16 a[86:87], v103 offset:53120
    s_waitcnt vmcnt(3) lgkmcnt(6)
    v_mfma_f32_32x32x16_bf16 v[0:15], a[64:67], a[16:19], v[0:15]
    ds_read_b64_tr_b16 a[88:89], v103 offset:55296
    ds_read_b64_tr_b16 a[90:91], v103 offset:56064
    v_mfma_f32_32x32x16_bf16 v[16:31], a[68:71], a[16:19], v[16:31]
    ds_read_b64_tr_b16 a[92:93], v103 offset:55360
    ds_read_b64_tr_b16 a[94:95], v103 offset:56128
    v_mfma_f32_32x32x16_bf16 v[32:47], a[72:75], a[16:19], v[32:47]
    ds_read_b64_tr_b16 a[96:97], v103 offset:55424
    ds_read_b64_tr_b16 a[98:99], v103 offset:56192
    s_waitcnt vmcnt(2) lgkmcnt(6)
    v_mfma_f32_32x32x16_bf16 v[0:15], a[76:79], a[20:23], v[0:15]
    ds_read_b64_tr_b16 a[64:65], v103 offset:58368
    ds_read_b64_tr_b16 a[66:67], v103 offset:59136
    v_mfma_f32_32x32x16_bf16 v[16:31], a[80:83], a[20:23], v[16:31]
    ds_read_b64_tr_b16 a[68:69], v103 offset:58432
    ds_read_b64_tr_b16 a[70:71], v103 offset:59200
    v_mfma_f32_32x32x16_bf16 v[32:47], a[84:87], a[20:23], v[32:47]
    ds_read_b64_tr_b16 a[72:73], v103 offset:58496
    ds_read_b64_tr_b16 a[74:75], v103 offset:59264
    s_waitcnt vmcnt(1) lgkmcnt(6)
    v_mfma_f32_32x32x16_bf16 v[0:15], a[88:91], a[24:27], v[0:15]
    v_mfma_f32_32x32x16_bf16 v[16:31], a[92:95], a[24:27], v[16:31]
    v_mfma_f32_32x32x16_bf16 v[32:47], a[96:99], a[24:27], v[32:47]
    s_waitcnt vmcnt(0) lgkmcnt(0)
    s_lshl_b32 s72, s3, 2
    s_add_u32 s72, s72, 163376
    v_mov_b32 v124, s72
    ds_write_b32 v124, v124
    v_mfma_f32_32x32x16_bf16 v[0:15], a[64:67], a[28:31], v[0:15]
    v_mfma_f32_32x32x16_bf16 v[16:31], a[68:71], a[28:31], v[16:31]
    v_mfma_f32_32x32x16_bf16 v[32:47], a[72:75], a[28:31], v[32:47]
    s_nop 9
    v_pk_mul_f32 v[56:57], v[0:1], v[0:1]
    v_pk_mul_f32 v[58:59], v[2:3], v[2:3]
    v_pk_mul_f32 v[60:61], v[4:5], v[4:5]
    v_pk_mul_f32 v[62:63], v[6:7], v[6:7]
    v_pk_fma_f32 v[56:57], v[56:57], v[50:51], v[48:49] op_sel_hi:[1,0,0]
    v_pk_fma_f32 v[58:59], v[58:59], v[50:51], v[48:49] op_sel_hi:[1,0,0]
    v_pk_fma_f32 v[60:61], v[60:61], v[50:51], v[48:49] op_sel_hi:[1,0,0]
    v_pk_fma_f32 v[62:63], v[62:63], v[50:51], v[48:49] op_sel_hi:[1,0,0]
    v_pk_mul_f32 v[56:57], v[56:57], v[0:1]
    v_pk_mul_f32 v[58:59], v[58:59], v[2:3]
    v_pk_mul_f32 v[60:61], v[60:61], v[4:5]
    v_pk_mul_f32 v[62:63], v[62:63], v[6:7]
    v_exp_f32 v56, v56
    v_exp_f32 v57, v57
    v_exp_f32 v58, v58
    v_exp_f32 v59, v59
    v_exp_f32 v60, v60
    v_exp_f32 v61, v61
    v_exp_f32 v62, v62
    v_exp_f32 v63, v63
    v_pk_add_f32 v[56:57], v[56:57], v[52:53] op_sel_hi:[1,0]
    v_pk_add_f32 v[58:59], v[58:59], v[52:53] op_sel_hi:[1,0]
    v_pk_add_f32 v[60:61], v[60:61], v[52:53] op_sel_hi:[1,0]
    v_pk_add_f32 v[62:63], v[62:63], v[52:53] op_sel_hi:[1,0]
    v_rcp_f32 v56, v56
    v_rcp_f32 v57, v57
    v_rcp_f32 v58, v58
    v_rcp_f32 v59, v59
    v_rcp_f32 v60, v60
    v_rcp_f32 v61, v61
    v_rcp_f32 v62, v62
    v_rcp_f32 v63, v63
    v_pk_mul_f32 v[56:57], v[56:57], v[0:1]
    v_pk_mul_f32 v[58:59], v[58:59], v[2:3]
    v_pk_mul_f32 v[60:61], v[60:61], v[4:5]
    v_pk_mul_f32 v[62:63], v[62:63], v[6:7]
    v_cvt_pk_bf16_f32 v64, v56, v57
    v_cvt_pk_bf16_f32 v65, v58, v59
    v_cvt_pk_bf16_f32 v66, v60, v61
    v_cvt_pk_bf16_f32 v67, v62, v63
    buffer_store_dwordx4 v[64:67], v105, s[44:47], s76 offen offset:0 sc1
    v_pk_mul_f32 v[68:69], v[8:9], v[8:9]
    v_pk_mul_f32 v[70:71], v[10:11], v[10:11]
    v_pk_mul_f32 v[72:73], v[12:13], v[12:13]
    v_pk_mul_f32 v[74:75], v[14:15], v[14:15]
    v_pk_fma_f32 v[68:69], v[68:69], v[50:51], v[48:49] op_sel_hi:[1,0,0]
    v_pk_fma_f32 v[70:71], v[70:71], v[50:51], v[48:49] op_sel_hi:[1,0,0]
    v_pk_fma_f32 v[72:73], v[72:73], v[50:51], v[48:49] op_sel_hi:[1,0,0]
    v_pk_fma_f32 v[74:75], v[74:75], v[50:51], v[48:49] op_sel_hi:[1,0,0]
    v_pk_mul_f32 v[68:69], v[68:69], v[8:9]
    v_pk_mul_f32 v[70:71], v[70:71], v[10:11]
    v_pk_mul_f32 v[72:73], v[72:73], v[12:13]
    v_pk_mul_f32 v[74:75], v[74:75], v[14:15]
    v_exp_f32 v68, v68
    v_exp_f32 v69, v69
    v_exp_f32 v70, v70
    v_exp_f32 v71, v71
    v_exp_f32 v72, v72
    v_exp_f32 v73, v73
    v_exp_f32 v74, v74
    v_exp_f32 v75, v75
    v_pk_add_f32 v[68:69], v[68:69], v[52:53] op_sel_hi:[1,0]
    v_pk_add_f32 v[70:71], v[70:71], v[52:53] op_sel_hi:[1,0]
    v_pk_add_f32 v[72:73], v[72:73], v[52:53] op_sel_hi:[1,0]
    v_pk_add_f32 v[74:75], v[74:75], v[52:53] op_sel_hi:[1,0]
    v_rcp_f32 v68, v68
    v_rcp_f32 v69, v69
    v_rcp_f32 v70, v70
    v_rcp_f32 v71, v71
    v_rcp_f32 v72, v72
    v_rcp_f32 v73, v73
    v_rcp_f32 v74, v74
    v_rcp_f32 v75, v75
    v_pk_mul_f32 v[68:69], v[68:69], v[8:9]
    v_pk_mul_f32 v[70:71], v[70:71], v[10:11]
    v_pk_mul_f32 v[72:73], v[72:73], v[12:13]
    v_pk_mul_f32 v[74:75], v[74:75], v[14:15]
    v_cvt_pk_bf16_f32 v76, v68, v69
    v_cvt_pk_bf16_f32 v77, v70, v71
    v_cvt_pk_bf16_f32 v78, v72, v73
    v_cvt_pk_bf16_f32 v79, v74, v75
    buffer_store_dwordx4 v[76:79], v105, s[44:47], s76 offen offset:512 sc1
    v_pk_mul_f32 v[56:57], v[16:17], v[16:17]
    v_pk_mul_f32 v[58:59], v[18:19], v[18:19]
    v_pk_mul_f32 v[60:61], v[20:21], v[20:21]
    v_pk_mul_f32 v[62:63], v[22:23], v[22:23]
    v_pk_fma_f32 v[56:57], v[56:57], v[50:51], v[48:49] op_sel_hi:[1,0,0]
    v_pk_fma_f32 v[58:59], v[58:59], v[50:51], v[48:49] op_sel_hi:[1,0,0]
    v_pk_fma_f32 v[60:61], v[60:61], v[50:51], v[48:49] op_sel_hi:[1,0,0]
    v_pk_fma_f32 v[62:63], v[62:63], v[50:51], v[48:49] op_sel_hi:[1,0,0]
    v_pk_mul_f32 v[56:57], v[56:57], v[16:17]
    v_pk_mul_f32 v[58:59], v[58:59], v[18:19]
    v_pk_mul_f32 v[60:61], v[60:61], v[20:21]
    v_pk_mul_f32 v[62:63], v[62:63], v[22:23]
    v_exp_f32 v56, v56
    v_exp_f32 v57, v57
    v_exp_f32 v58, v58
    v_exp_f32 v59, v59
    v_exp_f32 v60, v60
    v_exp_f32 v61, v61
    v_exp_f32 v62, v62
    v_exp_f32 v63, v63
    v_pk_add_f32 v[56:57], v[56:57], v[52:53] op_sel_hi:[1,0]
    v_pk_add_f32 v[58:59], v[58:59], v[52:53] op_sel_hi:[1,0]
    v_pk_add_f32 v[60:61], v[60:61], v[52:53] op_sel_hi:[1,0]
    v_pk_add_f32 v[62:63], v[62:63], v[52:53] op_sel_hi:[1,0]
    v_rcp_f32 v56, v56
    v_rcp_f32 v57, v57
    v_rcp_f32 v58, v58
    v_rcp_f32 v59, v59
    v_rcp_f32 v60, v60
    v_rcp_f32 v61, v61
    v_rcp_f32 v62, v62
    v_rcp_f32 v63, v63
    v_pk_mul_f32 v[56:57], v[56:57], v[16:17]
    v_pk_mul_f32 v[58:59], v[58:59], v[18:19]
    v_pk_mul_f32 v[60:61], v[60:61], v[20:21]
    v_pk_mul_f32 v[62:63], v[62:63], v[22:23]
    v_cvt_pk_bf16_f32 v64, v56, v57
    v_cvt_pk_bf16_f32 v65, v58, v59
    v_cvt_pk_bf16_f32 v66, v60, v61
    v_cvt_pk_bf16_f32 v67, v62, v63
    buffer_store_dwordx4 v[64:67], v105, s[44:47], s76 offen offset:1024 sc1
    v_pk_mul_f32 v[68:69], v[24:25], v[24:25]
    v_pk_mul_f32 v[70:71], v[26:27], v[26:27]
    v_pk_mul_f32 v[72:73], v[28:29], v[28:29]
    v_pk_mul_f32 v[74:75], v[30:31], v[30:31]
    v_pk_fma_f32 v[68:69], v[68:69], v[50:51], v[48:49] op_sel_hi:[1,0,0]
    v_pk_fma_f32 v[70:71], v[70:71], v[50:51], v[48:49] op_sel_hi:[1,0,0]
    v_pk_fma_f32 v[72:73], v[72:73], v[50:51], v[48:49] op_sel_hi:[1,0,0]
    v_pk_fma_f32 v[74:75], v[74:75], v[50:51], v[48:49] op_sel_hi:[1,0,0]
    v_pk_mul_f32 v[68:69], v[68:69], v[24:25]
    v_pk_mul_f32 v[70:71], v[70:71], v[26:27]
    v_pk_mul_f32 v[72:73], v[72:73], v[28:29]
    v_pk_mul_f32 v[74:75], v[74:75], v[30:31]
    v_exp_f32 v68, v68
    v_exp_f32 v69, v69
    v_exp_f32 v70, v70
    v_exp_f32 v71, v71
    v_exp_f32 v72, v72
    v_exp_f32 v73, v73
    v_exp_f32 v74, v74
    v_exp_f32 v75, v75
    v_pk_add_f32 v[68:69], v[68:69], v[52:53] op_sel_hi:[1,0]
    v_pk_add_f32 v[70:71], v[70:71], v[52:53] op_sel_hi:[1,0]
    v_pk_add_f32 v[72:73], v[72:73], v[52:53] op_sel_hi:[1,0]
    v_pk_add_f32 v[74:75], v[74:75], v[52:53] op_sel_hi:[1,0]
    v_rcp_f32 v68, v68
    v_rcp_f32 v69, v69
    v_rcp_f32 v70, v70
    v_rcp_f32 v71, v71
    v_rcp_f32 v72, v72
    v_rcp_f32 v73, v73
    v_rcp_f32 v74, v74
    v_rcp_f32 v75, v75
    v_pk_mul_f32 v[68:69], v[68:69], v[24:25]
    v_pk_mul_f32 v[70:71], v[70:71], v[26:27]
    v_pk_mul_f32 v[72:73], v[72:73], v[28:29]
    v_pk_mul_f32 v[74:75], v[74:75], v[30:31]
    v_cvt_pk_bf16_f32 v76, v68, v69
    v_cvt_pk_bf16_f32 v77, v70, v71
    v_cvt_pk_bf16_f32 v78, v72, v73
    v_cvt_pk_bf16_f32 v79, v74, v75
    buffer_store_dwordx4 v[76:79], v105, s[44:47], s76 offen offset:1536 sc1
    v_pk_mul_f32 v[56:57], v[32:33], v[32:33]
    v_pk_mul_f32 v[58:59], v[34:35], v[34:35]
    v_pk_mul_f32 v[60:61], v[36:37], v[36:37]
    v_pk_mul_f32 v[62:63], v[38:39], v[38:39]
    v_pk_fma_f32 v[56:57], v[56:57], v[50:51], v[48:49] op_sel_hi:[1,0,0]
    v_pk_fma_f32 v[58:59], v[58:59], v[50:51], v[48:49] op_sel_hi:[1,0,0]
    v_pk_fma_f32 v[60:61], v[60:61], v[50:51], v[48:49] op_sel_hi:[1,0,0]
    v_pk_fma_f32 v[62:63], v[62:63], v[50:51], v[48:49] op_sel_hi:[1,0,0]
    v_pk_mul_f32 v[56:57], v[56:57], v[32:33]
    v_pk_mul_f32 v[58:59], v[58:59], v[34:35]
    v_pk_mul_f32 v[60:61], v[60:61], v[36:37]
    v_pk_mul_f32 v[62:63], v[62:63], v[38:39]
    v_exp_f32 v56, v56
    v_exp_f32 v57, v57
    v_exp_f32 v58, v58
    v_exp_f32 v59, v59
    v_exp_f32 v60, v60
    v_exp_f32 v61, v61
    v_exp_f32 v62, v62
    v_exp_f32 v63, v63
    v_pk_add_f32 v[56:57], v[56:57], v[52:53] op_sel_hi:[1,0]
    v_pk_add_f32 v[58:59], v[58:59], v[52:53] op_sel_hi:[1,0]
    v_pk_add_f32 v[60:61], v[60:61], v[52:53] op_sel_hi:[1,0]
    v_pk_add_f32 v[62:63], v[62:63], v[52:53] op_sel_hi:[1,0]
    v_rcp_f32 v56, v56
    v_rcp_f32 v57, v57
    v_rcp_f32 v58, v58
    v_rcp_f32 v59, v59
    v_rcp_f32 v60, v60
    v_rcp_f32 v61, v61
    v_rcp_f32 v62, v62
    v_rcp_f32 v63, v63
    v_pk_mul_f32 v[56:57], v[56:57], v[32:33]
    v_pk_mul_f32 v[58:59], v[58:59], v[34:35]
    v_pk_mul_f32 v[60:61], v[60:61], v[36:37]
    v_pk_mul_f32 v[62:63], v[62:63], v[38:39]
    v_cvt_pk_bf16_f32 v64, v56, v57
    v_cvt_pk_bf16_f32 v65, v58, v59
    v_cvt_pk_bf16_f32 v66, v60, v61
    v_cvt_pk_bf16_f32 v67, v62, v63
    buffer_store_dwordx4 v[64:67], v105, s[44:47], s76 offen offset:2048 sc1
    v_pk_mul_f32 v[68:69], v[40:41], v[40:41]
    v_pk_mul_f32 v[70:71], v[42:43], v[42:43]
    v_pk_mul_f32 v[72:73], v[44:45], v[44:45]
    v_pk_mul_f32 v[74:75], v[46:47], v[46:47]
    v_pk_fma_f32 v[68:69], v[68:69], v[50:51], v[48:49] op_sel_hi:[1,0,0]
    v_pk_fma_f32 v[70:71], v[70:71], v[50:51], v[48:49] op_sel_hi:[1,0,0]
    v_pk_fma_f32 v[72:73], v[72:73], v[50:51], v[48:49] op_sel_hi:[1,0,0]
    v_pk_fma_f32 v[74:75], v[74:75], v[50:51], v[48:49] op_sel_hi:[1,0,0]
    v_pk_mul_f32 v[68:69], v[68:69], v[40:41]
    v_pk_mul_f32 v[70:71], v[70:71], v[42:43]
    v_pk_mul_f32 v[72:73], v[72:73], v[44:45]
    v_pk_mul_f32 v[74:75], v[74:75], v[46:47]
    v_exp_f32 v68, v68
    v_exp_f32 v69, v69
    v_exp_f32 v70, v70
    v_exp_f32 v71, v71
    v_exp_f32 v72, v72
    v_exp_f32 v73, v73
    v_exp_f32 v74, v74
    v_exp_f32 v75, v75
    v_pk_add_f32 v[68:69], v[68:69], v[52:53] op_sel_hi:[1,0]
    v_pk_add_f32 v[70:71], v[70:71], v[52:53] op_sel_hi:[1,0]
    v_pk_add_f32 v[72:73], v[72:73], v[52:53] op_sel_hi:[1,0]
    v_pk_add_f32 v[74:75], v[74:75], v[52:53] op_sel_hi:[1,0]
    v_rcp_f32 v68, v68
    v_rcp_f32 v69, v69
    v_rcp_f32 v70, v70
    v_rcp_f32 v71, v71
    v_rcp_f32 v72, v72
    v_rcp_f32 v73, v73
    v_rcp_f32 v74, v74
    v_rcp_f32 v75, v75
    v_pk_mul_f32 v[68:69], v[68:69], v[40:41]
    v_pk_mul_f32 v[70:71], v[70:71], v[42:43]
    v_pk_mul_f32 v[72:73], v[72:73], v[44:45]
    v_pk_mul_f32 v[74:75], v[74:75], v[46:47]
    s_lshl_b32 s72, s3, 2
    s_add_u32 s72, s72, 163392
    v_mov_b32 v124, s72
    ds_write_b32 v124, v124
    v_cvt_pk_bf16_f32 v76, v68, v69
    v_cvt_pk_bf16_f32 v77, v70, v71
    v_cvt_pk_bf16_f32 v78, v72, v73
    v_cvt_pk_bf16_f32 v79, v74, v75
    buffer_store_dwordx4 v[76:79], v105, s[44:47], s76 offen offset:2560 sc1
    s_setprio 0
    s_mov_b32 s74, s76
    v_lshrrev_b32 v2, 5, v127
    v_mul_u32_u24 v2, 49152, v2
    v_and_b32 v3, 31, v127
    v_lshl_add_u32 v2, v3, 7, v2
    v_lshrrev_b32 v0, 2, v127
    v_and_b32 v1, 3, v127
    v_mul_u32_u24 v110, 1280, v0
    v_lshl_add_u32 v110, v1, 4, v110
    v_mul_u32_u24 v113, 176, v0
    v_lshl_add_u32 v113, v1, 4, v113
    v_lshlrev_b32 v116, 3, v127
    v_and_b32 v0, 15, v127
    v_lshrrev_b32 v1, 4, v127
    v_mul_u32_u24 v112, 176, v0
    v_lshl_add_u32 v112, v1, 3, v112
    s_lshl_b32 s65, s62, 2
    s_add_u32 s65, s65, s3
    s_mul_i32 s65, s65, 20480
    s_mul_i32 s7, s63, 160
    s_add_u32 s65, s65, s7
    v_add_u32 v110, s65, v110
    v_lshl_add_u32 v117, v1, 3, s7
    v_min_u32 v118, 19, v127
    s_mul_i32 s7, s63, 2560
    s_add_u32 s7, s7, 16326656
    v_lshl_add_u32 v118, v118, 7, s7
    v_lshrrev_b32 v0, 1, v127
    v_lshlrev_b32 v115, 12, v0
    v_add_u32 v115, v115, v108
    s_mul_i32 s7, s3, 2560
    s_add_u32 s7, s7, 152576
    v_add_u32 v114, s7, v126
    v_add_u32 v116, s7, v116
    s_mul_i32 s76, s63, 327680
    s_lshl_b32 s7, s62, 7
    s_add_u32 s76, s76, s7
    s_lshl_b32 s7, s3, 5
    s_add_u32 s76, s76, s7
    s_add_u32 s76, s76, 13631488
    s_mul_i32 s7, s3, 15360
    s_add_u32 s7, s7, 91136
    v_add_u32 v111, s7, v126
    v_add_u32 v112, s7, v112
    v_add_u32 v113, s7, v113
    s_mul_i32 s48, s16, 15360
    s_add_u32 s48, s48, 91136
    s_mul_i32 s49, s17, 15360
    s_add_u32 s49, s49, 96256
    s_mul_i32 s50, s18, 15360
    s_add_u32 s50, s50, 101376
    s_mov_b32 s56, s36
    s_mov_b32 s57, s37
    s_mov_b32 s58, 2621440
    s_mov_b32 s59, 0x20000
    s_waitcnt vmcnt(0)
    v_mov_b32 v124, s60
    s_mov_b64 exec, 1
    buffer_store_dword v124, v126, s[44:47], s79 offen sc1
    s_mov_b64 exec, -1
    v_mov_b32 v124, 163332
    s_mov_b32 s73, 0
L_lw13:
    ds_read_b32 v125, v124
    s_add_u32 s73, s73, 1
    s_waitcnt lgkmcnt(0)
    v_cmp_eq_u32 vcc, 0, v125
    s_nop 1
    s_cbranch_vccz L_lw13_ok
    s_sleep 1
    s_cmp_lt_u32 s73, 3200000
    s_cbranch_scc1 L_lw13
L_lw13_ok:
    buffer_load_dwordx4 a[0:3], v106, s[44:47], s10 offen sc1
    s_add_u32 s71, s10, 49152
    buffer_load_dwordx4 a[4:7], v106, s[44:47], s71 offen sc1
    s_add_u32 s71, s10, 98304
    buffer_load_dwordx4 a[8:11], v106, s[44:47], s71 offen sc1
    s_add_u32 s71, s10, 147456
    buffer_load_dwordx4 a[12:15], v106, s[44:47], s71 offen sc1
    s_add_u32 s71, s10, 196608
    buffer_load_dwordx4 a[16:19], v106, s[44:47], s71 offen sc1
    buffer_load_dwordx4 a[20:23], v106, s[44:47], s11 offen sc1
    s_add_u32 s71, s11, 49152
    buffer_load_dwordx4 a[24:27], v106, s[44:47], s71 offen sc1
    s_add_u32 s71, s11, 98304
    buffer_load_dwordx4 a[28:31], v106, s[44:47], s71 offen sc1
    s_add_u32 s71, s11, 147456
    buffer_load_dwordx4 a[32:35], v106, s[44:47], s71 offen sc1
    s_add_u32 s71, s11, 196608
    buffer_load_dwordx4 a[36:39], v106, s[44:47], s71 offen sc1
    buffer_load_dwordx4 a[40:43], v106, s[44:47], s12 offen sc1
    s_add_u32 s71, s12, 49152
    buffer_load_dwordx4 a[44:47], v106, s[44:47], s71 offen sc1
    s_add_u32 s71, s12, 98304
    buffer_load_dwordx4 a[48:51], v106, s[44:47], s71 offen sc1
    s_add_u32 s71, s12, 147456
    buffer_load_dwordx4 a[52:55], v106, s[44:47], s71 offen sc1
    s_add_u32 s71, s12, 196608
    buffer_load_dwordx4 a[56:59], v106, s[44:47], s71 offen sc1
    buffer_load_dwordx4 a[60:63], v106, s[44:47], s13 offen sc1
    s_add_u32 s71, s13, 49152
    buffer_load_dwordx4 a[64:67], v106, s[44:47], s71 offen sc1
    s_add_u32 s71, s13, 98304
    buffer_load_dwordx4 a[68:71], v106, s[44:47], s71 offen sc1
    s_add_u32 s71, s13, 147456
    buffer_load_dwordx4 a[72:75], v106, s[44:47], s71 offen sc1
    s_add_u32 s71, s13, 196608
    buffer_load_dwordx4 a[76:79], v106, s[44:47], s71 offen sc1
    buffer_load_dwordx4 a[80:83], v106, s[44:47], s14 offen sc1
    s_add_u32 s71, s14, 49152
    buffer_load_dwordx4 a[84:87], v106, s[44:47], s71 offen sc1
    s_add_u32 s71, s14, 98304
    buffer_load_dwordx4 a[88:91], v106, s[44:47], s71 offen sc1
    s_add_u32 s71, s14, 147456
    buffer_load_dwordx4 a[92:95], v106, s[44:47], s71 offen sc1
    s_add_u32 s71, s14, 196608
    buffer_load_dwordx4 a[96:99], v106, s[44:47], s71 offen sc1
    buffer_load_dwordx4 a[100:103], v106, s[44:47], s15 offen sc1
    s_add_u32 s71, s15, 49152
    buffer_load_dwordx4 a[104:107], v106, s[44:47], s71 offen sc1
    s_add_u32 s71, s15, 98304
    buffer_load_dwordx4 a[108:111], v106, s[44:47], s71 offen sc1
    s_add_u32 s71, s15, 147456
    buffer_load_dwordx4 a[112:115], v106, s[44:47], s71 offen sc1
    s_add_u32 s71, s15, 196608
    buffer_load_dwordx4 a[116:119], v106, s[44:47], s71 offen sc1
    s_cmp_lg_u32 s3, 0
    s_cbranch_scc1 L_gate14_w
    v_mov_b32 v124, 163356
    s_mov_b32 s73, 0
L_lw15:
    ds_read_b32 v125, v124
    s_add_u32 s73, s73, 1
    s_waitcnt lgkmcnt(0)
    v_cmp_eq_u32 vcc, 0, v125
    s_nop 1
    s_cbranch_vccz L_lw15_ok
    s_sleep 1
    s_cmp_lt_u32 s73, 3200000
    s_cbranch_scc1 L_lw15
L_lw15_ok:
    s_mov_b32 s73, 0
L_poll16:
    buffer_load_dwordx4 v[120:123], v109, s[44:47], 0 offen sc1
    s_waitcnt vmcnt(0)
L_poll16_c:
    v_xor_b32 v120, s60, v120
    v_xor_b32 v121, s60, v121
    v_xor_b32 v122, s60, v122
    v_xor_b32 v123, s60, v123
    v_or_b32 v120, v120, v121
    v_or3_b32 v120, v120, v122, v123
    v_cmp_ne_u32 vcc, 0, v120
    s_nop 1
    s_cbranch_vccz L_poll16_ok
    s_add_u32 s73, s73, 1
    s_sleep 4
    s_cmp_lt_u32 s73, 50000
    s_cbranch_scc1 L_poll16
L_poll16_ok:
    v_mov_b32 v124, 163344
    ds_write_b32 v124, v124
    s_branch L_gate14_ok
L_gate14_w:
    v_mov_b32 v124, 163344
    s_mov_b32 s73, 0
L_lw17:
    ds_read_b32 v125, v124
    s_add_u32 s73, s73, 1
    s_waitcnt lgkmcnt(0)
    v_cmp_eq_u32 vcc, 0, v125
    s_nop 1
    s_cbranch_vccz L_lw17_ok
    s_sleep 1
    s_cmp_lt_u32 s73, 3200000
    s_cbranch_scc1 L_lw17
L_lw17_ok:
L_gate14_ok:
    s_add_u32 s71, s22, s10
    buffer_load_dwordx4 v[20:23], v126, s[44:47], s71 offen sc1
    s_add_u32 s71, s22, s11
    buffer_load_dwordx4 v[24:27], v126, s[44:47], s71 offen sc1
    s_add_u32 s71, s22, s12
    buffer_load_dwordx4 v[28:31], v126, s[44:47], s71 offen sc1
    s_add_u32 s71, s22, s13
    buffer_load_dwordx4 v[32:35], v126, s[44:47], s71 offen sc1
    s_add_u32 s71, s22, s14
    buffer_load_dwordx4 v[36:39], v126, s[44:47], s71 offen sc1
    s_add_u32 s71, s22, s15
    buffer_load_dwordx4 v[40:43], v126, s[44:47], s71 offen sc1
    s_add_u32 s71, s23, s10
    buffer_load_dwordx4 v[44:47], v126, s[44:47], s71 offen sc1
    s_add_u32 s71, s23, s11
    buffer_load_dwordx4 v[48:51], v126, s[44:47], s71 offen sc1
    s_add_u32 s71, s23, s12
    buffer_load_dwordx4 v[52:55], v126, s[44:47], s71 offen sc1
    s_add_u32 s71, s23, s13
    buffer_load_dwordx4 v[56:59], v126, s[44:47], s71 offen sc1
    s_add_u32 s71, s23, s14
    buffer_load_dwordx4 v[60:63], v126, s[44:47], s71 offen sc1
    s_add_u32 s71, s23, s15
    buffer_load_dwordx4 v[64:67], v126, s[44:47], s71 offen sc1
    s_add_u32 s71, s24, s10
    buffer_load_dwordx4 v[68:71], v126, s[44:47], s71 offen sc1
    s_add_u32 s71, s24, s11
    buffer_load_dwordx4 v[72:75], v126, s[44:47], s71 offen sc1
    s_add_u32 s71, s24, s12
    buffer_load_dwordx4 v[76:79], v126, s[44:47], s71 offen sc1
    s_add_u32 s71, s24, s13
    buffer_load_dwordx4 v[80:83], v126, s[44:47], s71 offen sc1
    v_and_b32 v124, 3, v127
    v_lshlrev_b32 v124, 2, v124
    v_add_u32 v124, 163376, v124
    s_mov_b32 s73, 0
L_lw18:
    ds_read_b32 v125, v124
    s_add_u32 s73, s73, 1
    s_waitcnt lgkmcnt(0)
    v_cmp_eq_u32 vcc, 0, v125
    s_nop 1
    s_cbranch_vccz L_lw18_ok
    s_sleep 1
    s_cmp_lt_u32 s73, 3200000
    s_cbranch_scc1 L_lw18
L_lw18_ok:
    s_waitcnt vmcnt(15)
    v_mfma_f32_16x16x32_bf16 v[0:3], a[0:3], v[20:23], 0
    v_mfma_f32_16x16x32_bf16 v[4:7], a[4:7], v[20:23], 0
    s_add_u32 s71, s24, s14
    buffer_load_dwordx4 v[84:87], v126, s[44:47], s71 offen sc1
    v_mfma_f32_16x16x32_bf16 v[8:11], a[8:11], v[20:23], 0
    s_add_u32 s71, s24, s15
    buffer_load_dwordx4 v[88:91], v126, s[44:47], s71 offen sc1
    v_mfma_f32_16x16x32_bf16 v[12:15], a[12:15], v[20:23], 0
    v_mfma_f32_16x16x32_bf16 v[16:19], a[16:19], v[20:23], 0
    s_waitcnt vmcnt(16)
    v_mfma_f32_16x16x32_bf16 v[0:3], a[20:23], v[24:27], v[0:3]
    v_mfma_f32_16x16x32_bf16 v[4:7], a[24:27], v[24:27], v[4:7]
    s_add_u32 s71, s25, s10
    buffer_load_dwordx4 v[92:95], v126, s[44:47], s71 offen sc1
    v_mfma_f32_16x16x32_bf16 v[8:11], a[28:31], v[24:27], v[8:11]
    s_add_u32 s71, s25, s11
    buffer_load_dwordx4 v[96:99], v126, s[44:47], s71 offen sc1
    v_mfma_f32_16x16x32_bf16 v[12:15], a[32:35], v[24:27], v[12:15]
    v_mfma_f32_16x16x32_bf16 v[16:19], a[36:39], v[24:27], v[16:19]
    s_waitcnt vmcnt(17)
    v_mfma_f32_16x16x32_bf16 v[0:3], a[40:43], v[28:31], v[0:3]
    v_mfma_f32_16x16x32_bf16 v[4:7], a[44:47], v[28:31], v[4:7]
    s_add_u32 s71, s25, s12
    buffer_load_dwordx4 v[100:103], v126, s[44:47], s71 offen sc1
    v_mfma_f32_16x16x32_bf16 v[8:11], a[48:51], v[28:31], v[8:11]
    s_add_u32 s71, s25, s13
    buffer_load_dwordx4 v[104:107], v126, s[44:47], s71 offen sc1
    v_mfma_f32_16x16x32_bf16 v[12:15], a[52:55], v[28:31], v[12:15]
    v_mfma_f32_16x16x32_bf16 v[16:19], a[56:59], v[28:31], v[16:19]
    s_waitcnt vmcnt(18)
    v_mfma_f32_16x16x32_bf16 v[0:3], a[60:63], v[32:35], v[0:3]
    v_mfma_f32_16x16x32_bf16 v[4:7], a[64:67], v[32:35], v[4:7]
    s_add_u32 s71, s25, s14
    buffer_load_dwordx4 a[120:123], v126, s[44:47], s71 offen sc1
    v_mfma_f32_16x16x32_bf16 v[8:11], a[68:71], v[32:35], v[8:11]
    s_add_u32 s71, s25, s15
    buffer_load_dwordx4 a[124:127], v126, s[44:47], s71 offen sc1
    v_mfma_f32_16x16x32_bf16 v[12:15], a[72:75], v[32:35], v[12:15]
    v_mfma_f32_16x16x32_bf16 v[16:19], a[76:79], v[32:35], v[16:19]
    s_waitcnt vmcnt(19)
    v_mfma_f32_16x16x32_bf16 v[0:3], a[80:83], v[36:39], v[0:3]
    v_mfma_f32_16x16x32_bf16 v[4:7], a[84:87], v[36:39], v[4:7]
    v_mfma_f32_16x16x32_bf16 v[8:11], a[88:91], v[36:39], v[8:11]
    v_mfma_f32_16x16x32_bf16 v[12:15], a[92:95], v[36:39], v[12:15]
    v_mfma_f32_16x16x32_bf16 v[16:19], a[96:99], v[36:39], v[16:19]
    s_waitcnt vmcnt(18)
    v_mfma_f32_16x16x32_bf16 v[0:3], a[100:103], v[40:43], v[0:3]
    v_mfma_f32_16x16x32_bf16 v[4:7], a[104:107], v[40:43], v[4:7]
    v_mfma_f32_16x16x32_bf16 v[8:11], a[108:111], v[40:43], v[8:11]
    v_mfma_f32_16x16x32_bf16 v[12:15], a[112:115], v[40:43], v[12:15]
    v_mfma_f32_16x16x32_bf16 v[16:19], a[116:119], v[40:43], v[16:19]
    s_waitcnt vmcnt(17)
    v_mfma_f32_16x16x32_bf16 v[20:23], a[0:3], v[44:47], 0
    v_mfma_f32_16x16x32_bf16 v[24:27], a[4:7], v[44:47], 0
    v_mfma_f32_16x16x32_bf16 v[28:31], a[8:11], v[44:47], 0
    v_mfma_f32_16x16x32_bf16 v[32:35], a[12:15], v[44:47], 0
    v_mfma_f32_16x16x32_bf16 v[36:39], a[16:19], v[44:47], 0
    s_waitcnt vmcnt(16)
    v_mfma_f32_16x16x32_bf16 v[20:23], a[20:23], v[48:51], v[20:23]
    v_mfma_f32_16x16x32_bf16 v[24:27], a[24:27], v[48:51], v[24:27]
    v_mfma_f32_16x16x32_bf16 v[28:31], a[28:31], v[48:51], v[28:31]
    v_mfma_f32_16x16x32_bf16 v[32:35], a[32:35], v[48:51], v[32:35]
    v_add_u32 v119, s48, v126
    ds_write_b128 v119, v[0:3] offset:0
    v_mfma_f32_16x16x32_bf16 v[36:39], a[36:39], v[48:51], v[36:39]
    s_waitcnt vmcnt(15)
    v_mfma_f32_16x16x32_bf16 v[20:23], a[40:43], v[52:55], v[20:23]
    v_mfma_f32_16x16x32_bf16 v[24:27], a[44:47], v[52:55], v[24:27]
    v_mfma_f32_16x16x32_bf16 v[28:31], a[48:51], v[52:55], v[28:31]
    v_mfma_f32_16x16x32_bf16 v[32:35], a[52:55], v[52:55], v[32:35]
    ds_write_b128 v119, v[4:7] offset:1024
    v_mfma_f32_16x16x32_bf16 v[36:39], a[56:59], v[52:55], v[36:39]
    s_waitcnt vmcnt(14)
    v_mfma_f32_16x16x32_bf16 v[20:23], a[60:63], v[56:59], v[20:23]
    v_mfma_f32_16x16x32_bf16 v[24:27], a[64:67], v[56:59], v[24:27]
    v_mfma_f32_16x16x32_bf16 v[28:31], a[68:71], v[56:59], v[28:31]
    v_mfma_f32_16x16x32_bf16 v[32:35], a[72:75], v[56:59], v[32:35]
    ds_write_b128 v119, v[8:11] offset:2048
    v_mfma_f32_16x16x32_bf16 v[36:39], a[76:79], v[56:59], v[36:39]
    s_waitcnt vmcnt(13)
    v_mfma_f32_16x16x32_bf16 v[20:23], a[80:83], v[60:63], v[20:23]
    v_mfma_f32_16x16x32_bf16 v[24:27], a[84:87], v[60:63], v[24:27]
    v_mfma_f32_16x16x32_bf16 v[28:31], a[88:91], v[60:63], v[28:31]
    v_mfma_f32_16x16x32_bf16 v[32:35], a[92:95], v[60:63], v[32:35]
    ds_write_b128 v119, v[12:15] offset:3072
    v_mfma_f32_16x16x32_bf16 v[36:39], a[96:99], v[60:63], v[36:39]
    s_waitcnt vmcnt(12)
    v_mfma_f32_16x16x32_bf16 v[20:23], a[100:103], v[64:67], v[20:23]
    v_mfma_f32_16x16x32_bf16 v[24:27], a[104:107], v[64:67], v[24:27]
    v_mfma_f32_16x16x32_bf16 v[28:31], a[108:111], v[64:67], v[28:31]
    v_mfma_f32_16x16x32_bf16 v[32:35], a[112:115], v[64:67], v[32:35]
    ds_write_b128 v119, v[16:19] offset:4096
    v_mfma_f32_16x16x32_bf16 v[36:39], a[116:119], v[64:67], v[36:39]
    s_waitcnt vmcnt(11)
    v_mfma_f32_16x16x32_bf16 v[0:3], a[0:3], v[68:71], 0
    v_mfma_f32_16x16x32_bf16 v[4:7], a[4:7], v[68:71], 0
    v_mfma_f32_16x16x32_bf16 v[8:11], a[8:11], v[68:71], 0
    v_mfma_f32_16x16x32_bf16 v[12:15], a[12:15], v[68:71], 0
    v_mfma_f32_16x16x32_bf16 v[16:19], a[16:19], v[68:71], 0
    s_waitcnt vmcnt(10)
    v_mfma_f32_16x16x32_bf16 v[0:3], a[20:23], v[72:75], v[0:3]
    v_mfma_f32_16x16x32_bf16 v[4:7], a[24:27], v[72:75], v[4:7]
    v_mfma_f32_16x16x32_bf16 v[8:11], a[28:31], v[72:75], v[8:11]
    v_mfma_f32_16x16x32_bf16 v[12:15], a[32:35], v[72:75], v[12:15]
    v_add_u32 v119, s49, v126
    ds_write_b128 v119, v[20:23] offset:0
    v_mfma_f32_16x16x32_bf16 v[16:19], a[36:39], v[72:75], v[16:19]
    s_waitcnt vmcnt(9)
    v_mfma_f32_16x16x32_bf16 v[0:3], a[40:43], v[76:79], v[0:3]
    v_mfma_f32_16x16x32_bf16 v[4:7], a[44:47], v[76:79], v[4:7]
    v_mfma_f32_16x16x32_bf16 v[8:11], a[48:51], v[76:79], v[8:11]
    v_mfma_f32_16x16x32_bf16 v[12:15], a[52:55], v[76:79], v[12:15]
    ds_write_b128 v119, v[24:27] offset:1024
    v_mfma_f32_16x16x32_bf16 v[16:19], a[56:59], v[76:79], v[16:19]
    s_waitcnt vmcnt(8)
    v_mfma_f32_16x16x32_bf16 v[0:3], a[60:63], v[80:83], v[0:3]
    v_mfma_f32_16x16x32_bf16 v[4:7], a[64:67], v[80:83], v[4:7]
    v_mfma_f32_16x16x32_bf16 v[8:11], a[68:71], v[80:83], v[8:11]
    v_mfma_f32_16x16x32_bf16 v[12:15], a[72:75], v[80:83], v[12:15]
    ds_write_b128 v119, v[28:31] offset:2048
    v_mfma_f32_16x16x32_bf16 v[16:19], a[76:79], v[80:83], v[16:19]
    s_waitcnt vmcnt(7)
    v_mfma_f32_16x16x32_bf16 v[0:3], a[80:83], v[84:87], v[0:3]
    v_mfma_f32_16x16x32_bf16 v[4:7], a[84:87], v[84:87], v[4:7]
    v_mfma_f32_16x16x32_bf16 v[8:11], a[88:91], v[84:87], v[8:11]
    v_mfma_f32_16x16x32_bf16 v[12:15], a[92:95], v[84:87], v[12:15]
    ds_write_b128 v119, v[32:35] offset:3072
    v_mfma_f32_16x16x32_bf16 v[16:19], a[96:99], v[84:87], v[16:19]
    s_waitcnt vmcnt(6)
    v_mfma_f32_16x16x32_bf16 v[0:3], a[100:103], v[88:91], v[0:3]
    v_mfma_f32_16x16x32_bf16 v[4:7], a[104:107], v[88:91], v[4:7]
    v_mfma_f32_16x16x32_bf16 v[8:11], a[108:111], v[88:91], v[8:11]
    v_mfma_f32_16x16x32_bf16 v[12:15], a[112:115], v[88:91], v[12:15]
    ds_write_b128 v119, v[36:39] offset:4096
    v_mfma_f32_16x16x32_bf16 v[16:19], a[116:119], v[88:91], v[16:19]
    s_waitcnt vmcnt(5)
    v_mfma_f32_16x16x32_bf16 v[20:23], a[0:3], v[92:95], 0
    v_mfma_f32_16x16x32_bf16 v[24:27], a[4:7], v[92:95], 0
    v_mfma_f32_16x16x32_bf16 v[28:31], a[8:11], v[92:95], 0
    v_mfma_f32_16x16x32_bf16 v[32:35], a[12:15], v[92:95], 0
    v_mfma_f32_16x16x32_bf16 v[36:39], a[16:19], v[92:95], 0
    s_waitcnt vmcnt(4)
    v_mfma_f32_16x16x32_bf16 v[20:23], a[20:23], v[96:99], v[20:23]
    v_mfma_f32_16x16x32_bf16 v[24:27], a[24:27], v[96:99], v[24:27]
    v_mfma_f32_16x16x32_bf16 v[28:31], a[28:31], v[96:99], v[28:31]
    v_mfma_f32_16x16x32_bf16 v[32:35], a[32:35], v[96:99], v[32:35]
    v_add_u32 v119, s50, v126
    ds_write_b128 v119, v[0:3] offset:0
    v_mfma_f32_16x16x32_bf16 v[36:39], a[36:39], v[96:99], v[36:39]
    s_waitcnt vmcnt(3)
    v_mfma_f32_16x16x32_bf16 v[20:23], a[40:43], v[100:103], v[20:23]
    v_mfma_f32_16x16x32_bf16 v[24:27], a[44:47], v[100:103], v[24:27]
    v_mfma_f32_16x16x32_bf16 v[28:31], a[48:51], v[100:103], v[28:31]
    v_mfma_f32_16x16x32_bf16 v[32:35], a[52:55], v[100:103], v[32:35]
    ds_write_b128 v119, v[4:7] offset:1024
    v_mfma_f32_16x16x32_bf16 v[36:39], a[56:59], v[100:103], v[36:39]
    s_waitcnt vmcnt(2)
    v_mfma_f32_16x16x32_bf16 v[20:23], a[60:63], v[104:107], v[20:23]
    v_mfma_f32_16x16x32_bf16 v[24:27], a[64:67], v[104:107], v[24:27]
    v_mfma_f32_16x16x32_bf16 v[28:31], a[68:71], v[104:107], v[28:31]
    v_mfma_f32_16x16x32_bf16 v[32:35], a[72:75], v[104:107], v[32:35]
    ds_write_b128 v119, v[8:11] offset:2048
    v_mfma_f32_16x16x32_bf16 v[36:39], a[76:79], v[104:107], v[36:39]
    s_waitcnt vmcnt(1)
    v_mfma_f32_16x16x32_bf16 v[20:23], a[80:83], a[120:123], v[20:23]
    v_mfma_f32_16x16x32_bf16 v[24:27], a[84:87], a[120:123], v[24:27]
    v_mfma_f32_16x16x32_bf16 v[28:31], a[88:91], a[120:123], v[28:31]
    v_mfma_f32_16x16x32_bf16 v[32:35], a[92:95], a[120:123], v[32:35]
    ds_write_b128 v119, v[12:15] offset:3072
    v_mfma_f32_16x16x32_bf16 v[36:39], a[96:99], a[120:123], v[36:39]
    s_waitcnt vmcnt(0)
    v_mfma_f32_16x16x32_bf16 v[20:23], a[100:103], a[124:127], v[20:23]
    v_mfma_f32_16x16x32_bf16 v[24:27], a[104:107], a[124:127], v[24:27]
    v_mfma_f32_16x16x32_bf16 v[28:31], a[108:111], a[124:127], v[28:31]
    v_mfma_f32_16x16x32_bf16 v[32:35], a[112:115], a[124:127], v[32:35]
    ds_write_b128 v119, v[16:19] offset:4096
    v_mfma_f32_16x16x32_bf16 v[36:39], a[116:119], a[124:127], v[36:39]
    s_lshl_b32 s72, s3, 2
    s_add_u32 s72, s72, 163424
    v_mov_b32 v124, s72
    ds_write_b32 v124, v124
    global_load_dwordx4 v[40:43], v110, s[8:9] offset:0
    global_load_dwordx4 v[44:47], v110, s[8:9] offset:64
    s_mov_b32 exec_lo, 0x33333333
    s_mov_b32 exec_hi, 0x33333333
    global_load_dwordx4 v[48:51], v110, s[8:9] offset:128
    s_mov_b64 exec, -1
    global_load_dwordx2 v[52:53], v117, s[34:35] offset:0
    global_load_dwordx2 v[54:55], v117, s[34:35] offset:32
    global_load_dwordx2 v[56:57], v117, s[34:35] offset:64
    global_load_dwordx2 v[58:59], v117, s[34:35] offset:96
    global_load_dwordx2 v[60:61], v117, s[34:35] offset:128
    s_mov_b32 s65, 0x00003f80
    s_mov_b32 s75, 0x3f800000
    v_and_b32 v124, 3, v127
    v_lshlrev_b32 v124, 2, v124
    v_add_u32 v124, 163424, v124
    s_mov_b32 s73, 0
L_lw19:
    ds_read_b32 v125, v124
    s_add_u32 s73, s73, 1
    s_waitcnt lgkmcnt(0)
    v_cmp_eq_u32 vcc, 0, v125
    s_nop 1
    s_cbranch_vccz L_lw19_ok
    s_sleep 1
    s_cmp_lt_u32 s73, 3200000
    s_cbranch_scc1 L_lw19
L_lw19_ok:
    ds_read_b128 v[76:79], v111 offset:0
    ds_read_b128 v[80:83], v111 offset:1024
    ds_read_b128 v[84:87], v111 offset:2048
    ds_read_b128 v[88:91], v111 offset:3072
    ds_read_b128 v[92:95], v111 offset:4096
    ds_read_b128 v[0:3], v111 offset:5120
    ds_read_b128 v[4:7], v111 offset:6144
    ds_read_b128 v[8:11], v111 offset:7168
    ds_read_b128 v[12:15], v111 offset:8192
    ds_read_b128 v[16:19], v111 offset:9216
    s_waitcnt lgkmcnt(9)
    v_add_f32 v20, v20, v76
    v_add_f32 v21, v21, v77
    v_add_f32 v22, v22, v78
    v_add_f32 v23, v23, v79
    s_waitcnt lgkmcnt(8)
    v_add_f32 v24, v24, v80
    v_add_f32 v25, v25, v81
    v_add_f32 v26, v26, v82
    v_add_f32 v27, v27, v83
    s_waitcnt lgkmcnt(7)
    v_add_f32 v28, v28, v84
    v_add_f32 v29, v29, v85
    v_add_f32 v30, v30, v86
    v_add_f32 v31, v31, v87
    s_waitcnt lgkmcnt(6)
    v_add_f32 v32, v32, v88
    v_add_f32 v33, v33, v89
    v_add_f32 v34, v34, v90
    v_add_f32 v35, v35, v91
    s_waitcnt lgkmcnt(5)
    v_add_f32 v36, v36, v92
    v_add_f32 v37, v37, v93
    v_add_f32 v38, v38, v94
    v_add_f32 v39, v39, v95
    ds_read_b128 v[76:79], v111 offset:10240
    ds_read_b128 v[80:83], v111 offset:11264
    ds_read_b128 v[84:87], v111 offset:12288
    ds_read_b128 v[88:91], v111 offset:13312
    ds_read_b128 v[92:95], v111 offset:14336
    s_waitcnt lgkmcnt(9)
    v_add_f32 v20, v20, v0
    v_add_f32 v21, v21, v1
    v_add_f32 v22, v22, v2
    v_add_f32 v23, v23, v3
    s_waitcnt lgkmcnt(8)
    v_add_f32 v24, v24, v4
    v_add_f32 v25, v25, v5
    v_add_f32 v26, v26, v6
    v_add_f32 v27, v27, v7
    s_waitcnt lgkmcnt(7)
    v_add_f32 v28, v28, v8
    v_add_f32 v29, v29, v9
    v_add_f32 v30, v30, v10
    v_add_f32 v31, v31, v11
    s_waitcnt lgkmcnt(6)
    v_add_f32 v32, v32, v12
    v_add_f32 v33, v33, v13
    v_add_f32 v34, v34, v14
    v_add_f32 v35, v35, v15
    s_waitcnt lgkmcnt(5)
    v_add_f32 v36, v36, v16
    v_add_f32 v37, v37, v17
    v_add_f32 v38, v38, v18
    v_add_f32 v39, v39, v19
    s_waitcnt lgkmcnt(4)
    v_add_f32 v20, v20, v76
    v_add_f32 v21, v21, v77
    v_add_f32 v22, v22, v78
    v_add_f32 v23, v23, v79
    s_waitcnt lgkmcnt(3)
    v_add_f32 v24, v24, v80
    v_add_f32 v25, v25, v81
    v_add_f32 v26, v26, v82
    v_add_f32 v27, v27, v83
    s_waitcnt lgkmcnt(2)
    v_add_f32 v28, v28, v84
    v_add_f32 v29, v29, v85
    v_add_f32 v30, v30, v86
    v_add_f32 v31, v31, v87
    s_waitcnt lgkmcnt(1)
    v_add_f32 v32, v32, v88
    v_add_f32 v33, v33, v89
    v_add_f32 v34, v34, v90
    v_add_f32 v35, v35, v91
    s_waitcnt lgkmcnt(0)
    v_add_f32 v36, v36, v92
    v_add_f32 v37, v37, v93
    v_add_f32 v38, v38, v94
    v_add_f32 v39, v39, v95
    s_waitcnt vmcnt(0)
    v_lshlrev_b32 v62, 16, v52
    v_and_b32 v63, 0xffff0000, v52
    v_add_f32 v20, v20, v62
    v_add_f32 v21, v21, v63
    v_lshlrev_b32 v62, 16, v53
    v_and_b32 v63, 0xffff0000, v53
    v_add_f32 v22, v22, v62
    v_add_f32 v23, v23, v63
    v_lshlrev_b32 v62, 16, v54
    v_and_b32 v63, 0xffff0000, v54
    v_add_f32 v24, v24, v62
    v_add_f32 v25, v25, v63
    v_lshlrev_b32 v62, 16, v55
    v_and_b32 v63, 0xffff0000, v55
    v_add_f32 v26, v26, v62
    v_add_f32 v27, v27, v63
    v_lshlrev_b32 v62, 16, v56
    v_and_b32 v63, 0xffff0000, v56
    v_add_f32 v28, v28, v62
    v_add_f32 v29, v29, v63
    v_lshlrev_b32 v62, 16, v57
    v_and_b32 v63, 0xffff0000, v57
    v_add_f32 v30, v30, v62
    v_add_f32 v31, v31, v63
    v_lshlrev_b32 v62, 16, v58
    v_and_b32 v63, 0xffff0000, v58
    v_add_f32 v32, v32, v62
    v_add_f32 v33, v33, v63
    v_lshlrev_b32 v62, 16, v59
    v_and_b32 v63, 0xffff0000, v59
    v_add_f32 v34, v34, v62
    v_add_f32 v35, v35, v63
    v_lshlrev_b32 v62, 16, v60
    v_and_b32 v63, 0xffff0000, v60
    v_add_f32 v36, v36, v62
    v_add_f32 v37, v37, v63
    v_lshlrev_b32 v62, 16, v61
    v_and_b32 v63, 0xffff0000, v61
    v_add_f32 v38, v38, v62
    v_add_f32 v39, v39, v63
    v_lshlrev_b32 v0, 16, v40
    v_and_b32 v1, 0xffff0000, v40
    v_lshlrev_b32 v2, 16, v41
    v_and_b32 v3, 0xffff0000, v41
    v_lshlrev_b32 v4, 16, v42
    v_and_b32 v5, 0xffff0000, v42
    v_lshlrev_b32 v6, 16, v43
    v_and_b32 v7, 0xffff0000, v43
    v_lshlrev_b32 v8, 16, v44
    v_and_b32 v9, 0xffff0000, v44
    v_lshlrev_b32 v10, 16, v45
    v_and_b32 v11, 0xffff0000, v45
    v_lshlrev_b32 v12, 16, v46
    v_and_b32 v13, 0xffff0000, v46
    v_lshlrev_b32 v14, 16, v47
    v_and_b32 v15, 0xffff0000, v47
    v_lshlrev_b32 v52, 16, v48
    v_and_b32 v53, 0xffff0000, v48
    v_lshlrev_b32 v54, 16, v49
    v_and_b32 v55, 0xffff0000, v49
    v_lshlrev_b32 v56, 16, v50
    v_and_b32 v57, 0xffff0000, v50
    v_lshlrev_b32 v58, 16, v51
    v_and_b32 v59, 0xffff0000, v51
    v_mov_b32 v16, 0xbfb8aa3b
    v_mov_b32 v18, 1.0
    s_sub_u32 s70, s3, 1
    s_and_b32 s70, s70, 3
    s_mul_i32 s7, s70, 22784
    v_add_u32 v119, s7, v126
    s_lshl_b32 s70, s70, 2
    s_lshl_b32 s72, s70, 2
    s_add_u32 s72, s72, 163456
    v_mov_b32 v124, s72
    s_mov_b32 s73, 0
L_lw20:
    ds_read_b32 v125, v124
    s_add_u32 s73, s73, 1
    s_waitcnt lgkmcnt(0)
    v_cmp_eq_u32 vcc, 0, v125
    s_nop 1
    s_cbranch_vccz L_lw20_ok
    s_sleep 1
    s_cmp_lt_u32 s73, 3200000
    s_cbranch_scc1 L_lw20
L_lw20_ok:
    ds_read_b128 v[76:79], v119 offset:0
    ds_read_b128 v[80:83], v119 offset:1024
    ds_read_b128 v[84:87], v119 offset:2048
    ds_read_b128 v[88:91], v119 offset:3072
    ds_read_b128 v[92:95], v119 offset:4096
    s_waitcnt lgkmcnt(4)
    v_add_f32 v20, v20, v76
    v_add_f32 v21, v21, v77
    v_add_f32 v22, v22, v78
    v_add_f32 v23, v23, v79
    s_waitcnt lgkmcnt(3)
    v_add_f32 v24, v24, v80
    v_add_f32 v25, v25, v81
    v_add_f32 v26, v26, v82
    v_add_f32 v27, v27, v83
    s_waitcnt lgkmcnt(2)
    v_add_f32 v28, v28, v84
    v_add_f32 v29, v29, v85
    v_add_f32 v30, v30, v86
    v_add_f32 v31, v31, v87
    s_waitcnt lgkmcnt(1)
    v_add_f32 v32, v32, v88
    v_add_f32 v33, v33, v89
    v_add_f32 v34, v34, v90
    v_add_f32 v35, v35, v91
    s_waitcnt lgkmcnt(0)
    v_add_f32 v36, v36, v92
    v_add_f32 v37, v37, v93
    v_add_f32 v38, v38, v94
    v_add_f32 v39, v39, v95
    s_sub_u32 s70, s3, 2
    s_and_b32 s70, s70, 3
    s_mul_i32 s7, s70, 22784
    v_add_u32 v119, s7, v126
    s_lshl_b32 s70, s70, 2
    s_lshl_b32 s72, s70, 2
    s_add_u32 s72, s72, 163460
    v_mov_b32 v124, s72
    s_mov_b32 s73, 0
L_lw21:
    ds_read_b32 v125, v124
    s_add_u32 s73, s73, 1
    s_waitcnt lgkmcnt(0)
    v_cmp_eq_u32 vcc, 0, v125
    s_nop 1
    s_cbranch_vccz L_lw21_ok
    s_sleep 1
    s_cmp_lt_u32 s73, 3200000
    s_cbranch_scc1 L_lw21
L_lw21_ok:
    ds_read_b128 v[76:79], v119 offset:5120
    ds_read_b128 v[80:83], v119 offset:6144
    ds_read_b128 v[84:87], v119 offset:7168
    ds_read_b128 v[88:91], v119 offset:8192
    ds_read_b128 v[92:95], v119 offset:9216
    s_waitcnt lgkmcnt(4)
    v_add_f32 v20, v20, v76
    v_add_f32 v21, v21, v77
    v_add_f32 v22, v22, v78
    v_add_f32 v23, v23, v79
    s_waitcnt lgkmcnt(3)
    v_add_f32 v24, v24, v80
    v_add_f32 v25, v25, v81
    v_add_f32 v26, v26, v82
    v_add_f32 v27, v27, v83
    s_waitcnt lgkmcnt(2)
    v_add_f32 v28, v28, v84
    v_add_f32 v29, v29, v85
    v_add_f32 v30, v30, v86
    v_add_f32 v31, v31, v87
    s_waitcnt lgkmcnt(1)
    v_add_f32 v32, v32, v88
    v_add_f32 v33, v33, v89
    v_add_f32 v34, v34, v90
    v_add_f32 v35, v35, v91
    s_waitcnt lgkmcnt(0)
    v_add_f32 v36, v36, v92
    v_add_f32 v37, v37, v93
    v_add_f32 v38, v38, v94
    v_add_f32 v39, v39, v95
    s_sub_u32 s70, s3, 3
    s_and_b32 s70, s70, 3
    s_mul_i32 s7, s70, 22784
    v_add_u32 v119, s7, v126
    s_lshl_b32 s70, s70, 2
    s_lshl_b32 s72, s70, 2
    s_add_u32 s72, s72, 163464
    v_mov_b32 v124, s72
    s_mov_b32 s73, 0
L_lw22:
    ds_read_b32 v125, v124
    s_add_u32 s73, s73, 1
    s_waitcnt lgkmcnt(0)
    v_cmp_eq_u32 vcc, 0, v125
    s_nop 1
    s_cbranch_vccz L_lw22_ok
    s_sleep 1
    s_cmp_lt_u32 s73, 3200000
    s_cbranch_scc1 L_lw22
L_lw22_ok:
    ds_read_b128 v[76:79], v119 offset:10240
    ds_read_b128 v[80:83], v119 offset:11264
    ds_read_b128 v[84:87], v119 offset:12288
    ds_read_b128 v[88:91], v119 offset:13312
    ds_read_b128 v[92:95], v119 offset:14336
    s_waitcnt lgkmcnt(4)
    v_add_f32 v20, v20, v76
    v_add_f32 v21, v21, v77
    v_add_f32 v22, v22, v78
    v_add_f32 v23, v23, v79
    s_waitcnt lgkmcnt(3)
    v_add_f32 v24, v24, v80
    v_add_f32 v25, v25, v81
    v_add_f32 v26, v26, v82
    v_add_f32 v27, v27, v83
    s_waitcnt lgkmcnt(2)
    v_add_f32 v28, v28, v84
    v_add_f32 v29, v29, v85
    v_add_f32 v30, v30, v86
    v_add_f32 v31, v31, v87
    s_waitcnt lgkmcnt(1)
    v_add_f32 v32, v32, v88
    v_add_f32 v33, v33, v89
    v_add_f32 v34, v34, v90
    v_add_f32 v35, v35, v91
    s_waitcnt lgkmcnt(0)
    v_add_f32 v36, v36, v92
    v_add_f32 v37, v37, v93
    v_add_f32 v38, v38, v94
    v_add_f32 v39, v39, v95
    s_sub_u32 s70, s3, 4
    s_and_b32 s70, s70, 3
    s_mul_i32 s7, s70, 22784
    v_add_u32 v119, s7, v126
    s_lshl_b32 s70, s70, 2
    s_lshl_b32 s72, s70, 2
    s_add_u32 s72, s72, 163468
    v_mov_b32 v124, s72
    s_mov_b32 s73, 0
L_lw23:
    ds_read_b32 v125, v124
    s_add_u32 s73, s73, 1
    s_waitcnt lgkmcnt(0)
    v_cmp_eq_u32 vcc, 0, v125
    s_nop 1
    s_cbranch_vccz L_lw23_ok
    s_sleep 1
    s_cmp_lt_u32 s73, 3200000
    s_cbranch_scc1 L_lw23
L_lw23_ok:
    ds_read_b128 v[76:79], v119 offset:15360
    ds_read_b128 v[80:83], v119 offset:16384
    ds_read_b128 v[84:87], v119 offset:17408
    ds_read_b128 v[88:91], v119 offset:18432
    ds_read_b128 v[92:95], v119 offset:19456
    s_waitcnt lgkmcnt(4)
    v_add_f32 v20, v20, v76
    v_add_f32 v21, v21, v77
    v_add_f32 v22, v22, v78
    v_add_f32 v23, v23, v79
    s_waitcnt lgkmcnt(3)
    v_add_f32 v24, v24, v80
    v_add_f32 v25, v25, v81
    v_add_f32 v26, v26, v82
    v_add_f32 v27, v27, v83
    s_waitcnt lgkmcnt(2)
    v_add_f32 v28, v28, v84
    v_add_f32 v29, v29, v85
    v_add_f32 v30, v30, v86
    v_add_f32 v31, v31, v87
    s_waitcnt lgkmcnt(1)
    v_add_f32 v32, v32, v88
    v_add_f32 v33, v33, v89
    v_add_f32 v34, v34, v90
    v_add_f32 v35, v35, v91
    s_waitcnt lgkmcnt(0)
    v_add_f32 v36, v36, v92
    v_add_f32 v37, v37, v93
    v_add_f32 v38, v38, v94
    v_add_f32 v39, v39, v95
    v_pk_mul_f32 v[76:77], v[20:21], v[16:17] op_sel_hi:[1,0]
    v_pk_mul_f32 v[78:79], v[22:23], v[16:17] op_sel_hi:[1,0]
    v_exp_f32 v76, v76
    v_exp_f32 v77, v77
    v_exp_f32 v78, v78
    v_exp_f32 v79, v79
    v_pk_mul_f32 v[80:81], v[24:25], v[16:17] op_sel_hi:[1,0]
    v_pk_mul_f32 v[82:83], v[26:27], v[16:17] op_sel_hi:[1,0]
    v_exp_f32 v80, v80
    v_exp_f32 v81, v81
    v_exp_f32 v82, v82
    v_exp_f32 v83, v83
    v_pk_mul_f32 v[84:85], v[28:29], v[16:17] op_sel_hi:[1,0]
    v_pk_mul_f32 v[86:87], v[30:31], v[16:17] op_sel_hi:[1,0]
    v_exp_f32 v84, v84
    v_exp_f32 v85, v85
    v_exp_f32 v86, v86
    v_exp_f32 v87, v87
    v_pk_mul_f32 v[88:89], v[32:33], v[16:17] op_sel_hi:[1,0]
    v_pk_mul_f32 v[90:91], v[34:35], v[16:17] op_sel_hi:[1,0]
    v_exp_f32 v88, v88
    v_exp_f32 v89, v89
    v_exp_f32 v90, v90
    v_exp_f32 v91, v91
    v_pk_mul_f32 v[92:93], v[36:37], v[16:17] op_sel_hi:[1,0]
    v_pk_mul_f32 v[94:95], v[38:39], v[16:17] op_sel_hi:[1,0]
    v_exp_f32 v92, v92
    v_exp_f32 v93, v93
    v_exp_f32 v94, v94
    v_exp_f32 v95, v95
    v_pk_add_f32 v[76:77], v[76:77], v[18:19] op_sel_hi:[1,0]
    v_pk_add_f32 v[78:79], v[78:79], v[18:19] op_sel_hi:[1,0]
    v_rcp_f32 v76, v76
    v_rcp_f32 v77, v77
    v_rcp_f32 v78, v78
    v_rcp_f32 v79, v79
    v_pk_add_f32 v[80:81], v[80:81], v[18:19] op_sel_hi:[1,0]
    v_pk_add_f32 v[82:83], v[82:83], v[18:19] op_sel_hi:[1,0]
    v_rcp_f32 v80, v80
    v_rcp_f32 v81, v81
    v_rcp_f32 v82, v82
    v_rcp_f32 v83, v83
    v_pk_add_f32 v[84:85], v[84:85], v[18:19] op_sel_hi:[1,0]
    v_pk_add_f32 v[86:87], v[86:87], v[18:19] op_sel_hi:[1,0]
    v_rcp_f32 v84, v84
    v_rcp_f32 v85, v85
    v_rcp_f32 v86, v86
    v_rcp_f32 v87, v87
    v_pk_add_f32 v[88:89], v[88:89], v[18:19] op_sel_hi:[1,0]
    v_pk_add_f32 v[90:91], v[90:91], v[18:19] op_sel_hi:[1,0]
    v_rcp_f32 v88, v88
    v_rcp_f32 v89, v89
    v_rcp_f32 v90, v90
    v_rcp_f32 v91, v91
    v_pk_add_f32 v[92:93], v[92:93], v[18:19] op_sel_hi:[1,0]
    v_pk_add_f32 v[94:95], v[94:95], v[18:19] op_sel_hi:[1,0]
    v_rcp_f32 v92, v92
    v_rcp_f32 v93, v93
    v_rcp_f32 v94, v94
    v_rcp_f32 v95, v95
    v_pk_mul_f32 v[76:77], v[76:77], v[20:21]
    v_pk_mul_f32 v[78:79], v[78:79], v[22:23]
    v_pk_mul_f32 v[80:81], v[80:81], v[24:25]
    v_pk_mul_f32 v[82:83], v[82:83], v[26:27]
    v_pk_mul_f32 v[84:85], v[84:85], v[28:29]
    v_pk_mul_f32 v[86:87], v[86:87], v[30:31]
    v_pk_mul_f32 v[88:89], v[88:89], v[32:33]
    v_pk_mul_f32 v[90:91], v[90:91], v[34:35]
    v_pk_mul_f32 v[92:93], v[92:93], v[36:37]
    v_pk_mul_f32 v[94:95], v[94:95], v[38:39]
    v_mov_b32 v124, 163348
    s_mov_b32 s73, 0
L_lw24:
    ds_read_b32 v125, v124
    s_add_u32 s73, s73, 1
    s_waitcnt lgkmcnt(0)
    v_cmp_eq_u32 vcc, 0, v125
    s_nop 1
    s_cbranch_vccz L_lw24_ok
    s_sleep 1
    s_cmp_lt_u32 s73, 3200000
    s_cbranch_scc1 L_lw24
L_lw24_ok:
    ds_read_b64_tr_b16 v[40:41], v116 offset:0
    ds_read_b64_tr_b16 v[42:43], v116 offset:512
    ds_read_b64_tr_b16 v[44:45], v116 offset:1024
    ds_read_b64_tr_b16 v[46:47], v116 offset:1536
    ds_read_b64_tr_b16 v[48:49], v116 offset:2048
    s_waitcnt lgkmcnt(4)
    v_lshlrev_b32 v64, 16, v40
    v_and_b32 v65, 0xffff0000, v40
    v_lshlrev_b32 v66, 16, v41
    v_and_b32 v67, 0xffff0000, v41
    v_pk_mul_f32 v[76:77], v[76:77], v[64:65]
    v_pk_mul_f32 v[78:79], v[78:79], v[66:67]
    v_cvt_pk_bf16_f32 v68, v76, v77
    v_cvt_pk_bf16_f32 v69, v78, v79
    ds_write_b64 v112, v[68:69] offset:0
    s_waitcnt lgkmcnt(4)
    v_lshlrev_b32 v70, 16, v42
    v_and_b32 v71, 0xffff0000, v42
    v_lshlrev_b32 v72, 16, v43
    v_and_b32 v73, 0xffff0000, v43
    v_pk_mul_f32 v[80:81], v[80:81], v[70:71]
    v_pk_mul_f32 v[82:83], v[82:83], v[72:73]
    v_cvt_pk_bf16_f32 v74, v80, v81
    v_cvt_pk_bf16_f32 v75, v82, v83
    ds_write_b64 v112, v[74:75] offset:32
    s_waitcnt lgkmcnt(4)
    v_lshlrev_b32 v64, 16, v44
    v_and_b32 v65, 0xffff0000, v44
    v_lshlrev_b32 v66, 16, v45
    v_and_b32 v67, 0xffff0000, v45
    v_pk_mul_f32 v[84:85], v[84:85], v[64:65]
    v_pk_mul_f32 v[86:87], v[86:87], v[66:67]
    v_cvt_pk_bf16_f32 v68, v84, v85
    v_cvt_pk_bf16_f32 v69, v86, v87
    ds_write_b64 v112, v[68:69] offset:64
    s_waitcnt lgkmcnt(4)
    v_lshlrev_b32 v70, 16, v46
    v_and_b32 v71, 0xffff0000, v46
    v_lshlrev_b32 v72, 16, v47
    v_and_b32 v73, 0xffff0000, v47
    v_pk_mul_f32 v[88:89], v[88:89], v[70:71]
    v_pk_mul_f32 v[90:91], v[90:91], v[72:73]
    v_cvt_pk_bf16_f32 v74, v88, v89
    v_cvt_pk_bf16_f32 v75, v90, v91
    ds_write_b64 v112, v[74:75] offset:96
    s_waitcnt lgkmcnt(4)
    v_lshlrev_b32 v64, 16, v48
    v_and_b32 v65, 0xffff0000, v48
    v_lshlrev_b32 v66, 16, v49
    v_and_b32 v67, 0xffff0000, v49
    v_pk_mul_f32 v[92:93], v[92:93], v[64:65]
    v_pk_mul_f32 v[94:95], v[94:95], v[66:67]
    v_cvt_pk_bf16_f32 v68, v92, v93
    v_cvt_pk_bf16_f32 v69, v94, v95
    ds_write_b64 v112, v[68:69] offset:128
    ds_read_b128 v[20:23], v113 offset:0
    ds_read_b128 v[24:27], v113 offset:64
    ds_read_b128 v[28:31], v113 offset:128
    s_waitcnt lgkmcnt(2)
    v_dot2_f32_bf16 v0, v20, s65, v0
    v_dot2_f32_bf16 v1, v20, s75, v1
    v_dot2_f32_bf16 v2, v21, s65, v2
    v_dot2_f32_bf16 v3, v21, s75, v3
    v_dot2_f32_bf16 v4, v22, s65, v4
    v_dot2_f32_bf16 v5, v22, s75, v5
    v_dot2_f32_bf16 v6, v23, s65, v6
    v_dot2_f32_bf16 v7, v23, s75, v7
    v_cvt_pk_bf16_f32 v76, v0, v1
    v_cvt_pk_bf16_f32 v77, v2, v3
    v_cvt_pk_bf16_f32 v78, v4, v5
    v_cvt_pk_bf16_f32 v79, v6, v7
    buffer_store_dwordx4 v[76:79], v110, s[56:59], 0 offen offset:0
    s_waitcnt lgkmcnt(1)
    v_dot2_f32_bf16 v8, v24, s65, v8
    v_dot2_f32_bf16 v9, v24, s75, v9
    v_dot2_f32_bf16 v10, v25, s65, v10
    v_dot2_f32_bf16 v11, v25, s75, v11
    v_dot2_f32_bf16 v12, v26, s65, v12
    v_dot2_f32_bf16 v13, v26, s75, v13
    v_dot2_f32_bf16 v14, v27, s65, v14
    v_dot2_f32_bf16 v15, v27, s75, v15
    v_cvt_pk_bf16_f32 v80, v8, v9
    v_cvt_pk_bf16_f32 v81, v10, v11
    v_cvt_pk_bf16_f32 v82, v12, v13
    v_cvt_pk_bf16_f32 v83, v14, v15
    buffer_store_dwordx4 v[80:83], v110, s[56:59], 0 offen offset:64
    s_waitcnt lgkmcnt(0)
    v_dot2_f32_bf16 v52, v28, s65, v52
    v_dot2_f32_bf16 v53, v28, s75, v53
    v_dot2_f32_bf16 v54, v29, s65, v54
    v_dot2_f32_bf16 v55, v29, s75, v55
    v_dot2_f32_bf16 v56, v30, s65, v56
    v_dot2_f32_bf16 v57, v30, s75, v57
    v_dot2_f32_bf16 v58, v31, s65, v58
    v_dot2_f32_bf16 v59, v31, s75, v59
    v_cvt_pk_bf16_f32 v84, v52, v53
    v_cvt_pk_bf16_f32 v85, v54, v55
    v_cvt_pk_bf16_f32 v86, v56, v57
    v_cvt_pk_bf16_f32 v87, v58, v59
    s_mov_b32 exec_lo, 0x33333333
    s_mov_b32 exec_hi, 0x33333333
    buffer_store_dwordx4 v[84:87], v110, s[56:59], 0 offen offset:128
    s_endpgm
L_S:
    s_lshl_b32 s7, s65, 5
    s_add_u32 s7, s7, s66
    s_lshr_b32 s40, s7, 1
    s_mul_i32 s40, s40, 5
    s_and_b32 s7, s7, 1
    s_mul_i32 s75, s7, 3
    s_add_u32 s40, s40, s75
    s_add_u32 s74, s40, s3
    s_add_u32 s7, s7, s3
    s_cmp_lt_u32 s7, 3
    s_cselect_b32 s61, s74, -1
    s_cmp_eq_u32 s3, 3
    s_cbranch_scc1 L_agent
    s_cmp_lt_i32 s61, 0
    s_cbranch_scc0 L_kgen
    s_lshl_b32 s72, s3, 2
    s_add_u32 s72, s72, 163536
    v_mov_b32 v124, s72
    ds_write_b32 v124, v124
    s_add_u32 s10, s51, 6
    s_sub_u32 s7, s10, 12
    s_cmp_ge_u32 s10, 12
    s_cselect_b32 s10, s7, s10
    s_sub_u32 s7, s10, 12
    s_cmp_ge_u32 s10, 12
    s_cselect_b32 s10, s7, s10
    s_lshl_b32 s10, s10, 10
    s_add_u32 s11, s10, 1024
    s_cmp_ge_u32 s11, 12288
    s_cselect_b32 s11, 0, s11
    s_add_u32 s12, s11, 1024
    s_cmp_ge_u32 s12, 12288
    s_cselect_b32 s12, 0, s12
    s_add_u32 s13, s12, 1024
    s_cmp_ge_u32 s13, 12288
    s_cselect_b32 s13, 0, s13
    s_add_u32 s14, s13, 1024
    s_cmp_ge_u32 s14, 12288
    s_cselect_b32 s14, 0, s14
    s_add_u32 s15, s14, 1024
    s_cmp_ge_u32 s15, 12288
    s_cselect_b32 s15, 0, s15
    s_mul_i32 s71, s63, 240
    s_mul_i32 s7, s3, 12
    s_add_u32 s71, s71, s7
    s_lshl_b32 s71, s71, 10
    s_add_u32 s71, s71, 5242880
    v_add_u32 v119, s71, v126
    s_mul_i32 s71, s3, 12288
    s_add_u32 s71, s71, 7340032
    s_add_u32 s16, s3, 1
    s_and_b32 s16, s16, 3
    s_lshl_b32 s70, s62, 2
    s_add_u32 s70, s70, s16
    s_mul_i32 s70, s70, 49152
    s_add_u32 s22, s70, s71
    s_add_u32 s17, s3, 2
    s_and_b32 s17, s17, 3
    s_lshl_b32 s70, s62, 2
    s_add_u32 s70, s70, s17
    s_mul_i32 s70, s70, 49152
    s_add_u32 s23, s70, s71
    s_add_u32 s18, s3, 3
    s_and_b32 s18, s18, 3
    s_lshl_b32 s70, s62, 2
    s_add_u32 s70, s70, s18
    s_mul_i32 s70, s70, 49152
    s_add_u32 s24, s70, s71
    s_add_u32 s19, s3, 4
    s_and_b32 s19, s19, 3
    s_lshl_b32 s70, s62, 2
    s_add_u32 s70, s70, s19
    s_mul_i32 s70, s70, 49152
    s_add_u32 s25, s70, s71
    s_mul_i32 s74, s3, 22784
    v_and_b32 v104, 15, v127
    v_lshrrev_b32 v105, 4, v127
    v_and_b32 v106, 3, v127
    v_lshrrev_b32 v107, 2, v127
    v_mul_u32_u24 v111, 10240, v107
    v_lshl_add_u32 v111, v106, 4, v111
    s_mul_i32 s7, s3, 655360
    s_lshl_b32 s71, s40, 4
    s_add_u32 s7, s7, s71
    s_add_u32 s7, s7, 2621440
    v_add_u32 v111, s7, v111
    v_mul_u32_u24 v118, 22784, v106
    v_lshlrev_b32 v107, 4, v107
    v_sub_u32 v118, v118, v107
    s_lshl_b32 s7, s3, 10
    s_sub_u32 s7, 21872, s7
    v_add_u32 v118, s7, v118
    v_mul_u32_u24 v112, 4640, v106
    v_lshrrev_b32 v107, 2, v104
    v_lshl_add_u32 v112, v107, 7, v112
    v_lshl_add_u32 v112, v105, 4, v112
    v_add_u32 v112, s74, v112
    v_lshlrev_b32 v113, 3, v104
    v_sub_u32 v113, s74, v113
    v_lshl_add_u32 v113, v105, 4, v113
    v_add_u32 v113, 18680, v113
    v_lshlrev_b32 v114, 3, v127
    v_sub_u32 v115, s74, v114
    v_add_u32 v115, 19064, v115
    v_add_u32 v116, s74, v126
    v_lshrrev_b32 v117, 5, v127
    v_mul_u32_u24 v117, 4128, v117
    v_add_u32 v117, v117, v116
    s_branch L_kdone
L_kgen:
    s_mul_i32 s65, s61, 384
    v_mul_u32_u24 v50, 6, v127
    v_and_b32 v50, -4, v50
    v_add_u32 v50, s65, v50
    s_lshl_b32 s65, s61, 1
    s_and_b32 s65, s65, 0xffc
    s_load_dword s42, s[22:23], s65
    s_load_dword s43, s[24:25], s65
    global_load_dwordx2 v[0:1], v50, s[10:11]
    global_load_dwordx2 v[2:3], v50, s[12:13]
    global_load_dwordx2 v[4:5], v50, s[14:15]
    global_load_dwordx2 v[6:7], v50, s[16:17]
    global_load_dwordx2 v[8:9], v50, s[18:19]
    global_load_dwordx2 v[10:11], v50, s[20:21]
    s_add_u32 s10, s51, 6
    s_sub_u32 s7, s10, 12
    s_cmp_ge_u32 s10, 12
    s_cselect_b32 s10, s7, s10
    s_sub_u32 s7, s10, 12
    s_cmp_ge_u32 s10, 12
    s_cselect_b32 s10, s7, s10
    s_lshl_b32 s10, s10, 10
    s_add_u32 s11, s10, 1024
    s_cmp_ge_u32 s11, 12288
    s_cselect_b32 s11, 0, s11
    s_add_u32 s12, s11, 1024
    s_cmp_ge_u32 s12, 12288
    s_cselect_b32 s12, 0, s12
    s_add_u32 s13, s12, 1024
    s_cmp_ge_u32 s13, 12288
    s_cselect_b32 s13, 0, s13
    s_add_u32 s14, s13, 1024
    s_cmp_ge_u32 s14, 12288
    s_cselect_b32 s14, 0, s14
    s_add_u32 s15, s14, 1024
    s_cmp_ge_u32 s15, 12288
    s_cselect_b32 s15, 0, s15
    s_mul_i32 s71, s63, 240
    s_mul_i32 s7, s3, 12
    s_add_u32 s71, s71, s7
    s_lshl_b32 s71, s71, 10
    s_add_u32 s71, s71, 5242880
    v_add_u32 v119, s71, v126
    s_mul_i32 s71, s3, 12288
    s_add_u32 s71, s71, 7340032
    s_add_u32 s16, s3, 1
    s_and_b32 s16, s16, 3
    s_lshl_b32 s70, s62, 2
    s_add_u32 s70, s70, s16
    s_mul_i32 s70, s70, 49152
    s_add_u32 s22, s70, s71
    s_add_u32 s17, s3, 2
    s_and_b32 s17, s17, 3
    s_lshl_b32 s70, s62, 2
    s_add_u32 s70, s70, s17
    s_mul_i32 s70, s70, 49152
    s_add_u32 s23, s70, s71
    s_add_u32 s18, s3, 3
    s_and_b32 s18, s18, 3
    s_lshl_b32 s70, s62, 2
    s_add_u32 s70, s70, s18
    s_mul_i32 s70, s70, 49152
    s_add_u32 s24, s70, s71
    s_add_u32 s19, s3, 4
    s_and_b32 s19, s19, 3
    s_lshl_b32 s70, s62, 2
    s_add_u32 s70, s70, s19
    s_mul_i32 s70, s70, 49152
    s_add_u32 s25, s70, s71
    s_mul_i32 s74, s3, 22784
    v_and_b32 v104, 15, v127
    v_lshrrev_b32 v105, 4, v127
    v_and_b32 v106, 3, v127
    v_lshrrev_b32 v107, 2, v127
    v_mul_u32_u24 v111, 10240, v107
    v_lshl_add_u32 v111, v106, 4, v111
    s_mul_i32 s7, s3, 655360
    s_lshl_b32 s71, s40, 4
    s_add_u32 s7, s7, s71
    s_add_u32 s7, s7, 2621440
    v_add_u32 v111, s7, v111
    v_mul_u32_u24 v118, 22784, v106
    v_lshlrev_b32 v107, 4, v107
    v_sub_u32 v118, v118, v107
    s_lshl_b32 s7, s3, 10
    s_sub_u32 s7, 21872, s7
    v_add_u32 v118, s7, v118
    v_mul_u32_u24 v112, 4640, v106
    v_lshrrev_b32 v107, 2, v104
    v_lshl_add_u32 v112, v107, 7, v112
    v_lshl_add_u32 v112, v105, 4, v112
    v_add_u32 v112, s74, v112
    v_lshlrev_b32 v113, 3, v104
    v_sub_u32 v113, s74, v113
    v_lshl_add_u32 v113, v105, 4, v113
    v_add_u32 v113, 18680, v113
    v_lshlrev_b32 v114, 3, v127
    v_sub_u32 v115, s74, v114
    v_add_u32 v115, 19064, v115
    v_add_u32 v116, s74, v126
    v_lshrrev_b32 v117, 5, v127
    v_mul_u32_u24 v117, 4128, v117
    v_add_u32 v117, v117, v116
    v_accvgpr_write_b32 a64, 0
    v_accvgpr_write_b32 a65, 0
    v_accvgpr_write_b32 a66, 0
    v_accvgpr_write_b32 a67, 0
    v_accvgpr_write_b32 a68, 0
    v_accvgpr_write_b32 a69, 0
    v_accvgpr_write_b32 a70, 0
    v_accvgpr_write_b32 a71, 0
    v_accvgpr_write_b32 a72, 0
    v_accvgpr_write_b32 a73, 0
    v_accvgpr_write_b32 a74, 0
    v_accvgpr_write_b32 a75, 0
    s_mul_i32 s68, s3, 4352
    s_add_u32 s68, s68, 122880
    v_lshl_add_u32 v44, v127, 2, s68
    v_add_u32 v45, 1088, v44
    v_add_u32 v46, 2176, v44
    v_add_u32 v47, 3264, v44
    v_mul_u32_u24 v50, 272, v104
    v_lshl_add_u32 v50, v105, 4, v50
    v_add_u32 v48, s68, v50
    s_mov_b32 s65, 0x3fb8aa3b
    s_mov_b32 s66, 0x3e22f983
    v_and_b32 v50, 1, v127
    v_lshlrev_b32 v50, 4, v50
    s_waitcnt lgkmcnt(0)
    s_and_b32 s7, s61, 1
    s_lshl_b32 s7, s7, 4
    s_lshr_b32 s42, s42, s7
    s_lshl_b32 s42, s42, 16
    s_lshr_b32 s43, s43, s7
    s_and_b32 s43, s43, 0xffff
    v_mov_b32 v36, s42
    v_mul_f32 v37, s65, v36
    v_fma_f32 v38, v36, s65, -v37
    v_fmac_f32 v38, 0x32a57060, v36
    v_rndne_f32 v39, v37
    v_sub_f32 v37, v37, v39
    v_add_f32 v37, v37, v38
    v_exp_f32 v37, v37
    v_cvt_i32_f32 v39, v39
    v_ldexp_f32 v37, v37, v39
    v_cvt_pk_bf16_f32 v37, v37, v37
    v_and_b32 v37, 0xffff0000, v37
    s_nop 0
    v_readfirstlane_b32 s64, v37
    s_waitcnt vmcnt(0)
    v_lshrrev_b64 v[0:1], v50, v[0:1]
    v_lshrrev_b64 v[2:3], v50, v[2:3]
    v_lshrrev_b64 v[4:5], v50, v[4:5]
    v_lshrrev_b64 v[6:7], v50, v[6:7]
    v_lshrrev_b64 v[8:9], v50, v[8:9]
    v_lshrrev_b64 v[10:11], v50, v[10:11]
    v_lshlrev_b32 v12, 16, v0
    v_lshlrev_b32 v13, 16, v2
    v_lshlrev_b32 v14, 16, v4
    v_lshlrev_b32 v15, 16, v6
    v_lshlrev_b32 v16, 16, v8
    v_lshlrev_b32 v17, 16, v10
    v_alignbit_b32 v0, v1, v0, 16
    v_alignbit_b32 v2, v3, v2, 16
    v_alignbit_b32 v4, v5, v4, 16
    v_alignbit_b32 v6, v7, v6, 16
    v_alignbit_b32 v8, v9, v8, 16
    v_alignbit_b32 v10, v11, v10, 16
    v_mul_f32 v12, s64, v12
    v_mul_f32 v13, s64, v13
    v_mul_f32 v14, s64, v14
    v_mul_f32 v15, s64, v15
    v_mul_f32 v28, v16, v14
    v_mul_f32 v29, v16, v15
    v_fma_f32 v28, -v17, v15, v28
    v_fmac_f32 v29, v17, v14
    v_mul_f32 v36, s65, v12
    v_mul_f32 v37, s66, v13
    v_fma_f32 v38, v13, s66, -v37
    v_fmac_f32 v38, 0x31dc9c88, v13
    v_mul_f32 v12, 0x41000000, v37
    v_mul_f32 v13, 0x41000000, v36
    v_fract_f32 v12, v12
    v_fmac_f32 v12, 0x41000000, v38
    v_exp_f32 v13, v13
    v_cos_f32 v24, v12
    v_sin_f32 v25, v12
    v_fract_f32 v14, v37
    v_add_f32 v14, v14, v38
    v_exp_f32 v15, v36
    v_cos_f32 v18, v14
    v_sin_f32 v19, v14
    v_mul_f32 v16, 0x43000000, v37
    v_mul_f32 v17, 0x43000000, v36
    v_fract_f32 v16, v16
    v_fmac_f32 v16, 0x43000000, v38
    v_exp_f32 v17, v17
    v_cos_f32 v26, v16
    v_sin_f32 v27, v16
    v_mul_f32 v24, v24, v13
    v_mul_f32 v25, v25, v13
    v_mul_f32 v18, v18, v15
    v_mul_f32 v19, v19, v15
    v_mul_f32 v26, v26, v17
    v_mul_f32 v27, v27, v17
    s_mov_b32 s67, 0
.p2align 3
L_kgen_loop:
    v_mov_b32 v40, 0x3f80
    v_cvt_pk_bf16_f32 v41, v24, v25
    ds_write2_b32 v44, v40, v41 offset0:0 offset1:68
    v_pk_mul_f32 v[32:33], v[24:25], v[24:25] op_sel:[0,0] op_sel_hi:[0,1]
    v_pk_fma_f32 v[32:33], v[24:25], v[24:25], v[32:33] op_sel:[1,1,0] op_sel_hi:[1,0,1] neg_lo:[1,0,0]
    v_cvt_pk_bf16_f32 v42, v32, v33
    v_pk_mul_f32 v[34:35], v[32:33], v[24:25] op_sel:[0,0] op_sel_hi:[0,1]
    v_pk_fma_f32 v[34:35], v[32:33], v[24:25], v[34:35] op_sel:[1,1,0] op_sel_hi:[1,0,1] neg_lo:[1,0,0]
    v_cvt_pk_bf16_f32 v43, v34, v35
    ds_write2_b32 v44, v42, v43 offset0:136 offset1:204
    v_pk_mul_f32 v[32:33], v[34:35], v[24:25] op_sel:[0,0] op_sel_hi:[0,1]
    v_pk_fma_f32 v[32:33], v[34:35], v[24:25], v[32:33] op_sel:[1,1,0] op_sel_hi:[1,0,1] neg_lo:[1,0,0]
    v_cvt_pk_bf16_f32 v40, v32, v33
    v_pk_mul_f32 v[34:35], v[32:33], v[24:25] op_sel:[0,0] op_sel_hi:[0,1]
    v_pk_fma_f32 v[34:35], v[32:33], v[24:25], v[34:35] op_sel:[1,1,0] op_sel_hi:[1,0,1] neg_lo:[1,0,0]
    v_cvt_pk_bf16_f32 v41, v34, v35
    ds_write2_b32 v45, v40, v41 offset0:0 offset1:68
    v_pk_mul_f32 v[32:33], v[34:35], v[24:25] op_sel:[0,0] op_sel_hi:[0,1]
    v_pk_fma_f32 v[32:33], v[34:35], v[24:25], v[32:33] op_sel:[1,1,0] op_sel_hi:[1,0,1] neg_lo:[1,0,0]
    v_cvt_pk_bf16_f32 v42, v32, v33
    v_pk_mul_f32 v[34:35], v[32:33], v[24:25] op_sel:[0,0] op_sel_hi:[0,1]
    v_pk_fma_f32 v[34:35], v[32:33], v[24:25], v[34:35] op_sel:[1,1,0] op_sel_hi:[1,0,1] neg_lo:[1,0,0]
    v_cvt_pk_bf16_f32 v43, v34, v35
    ds_write2_b32 v45, v42, v43 offset0:136 offset1:204
    v_pk_mul_f32 v[32:33], v[34:35], v[24:25] op_sel:[0,0] op_sel_hi:[0,1]
    v_pk_fma_f32 v[32:33], v[34:35], v[24:25], v[32:33] op_sel:[1,1,0] op_sel_hi:[1,0,1] neg_lo:[1,0,0]
    v_cvt_pk_bf16_f32 v40, v32, v33
    v_pk_mul_f32 v[34:35], v[32:33], v[24:25] op_sel:[0,0] op_sel_hi:[0,1]
    v_pk_fma_f32 v[34:35], v[32:33], v[24:25], v[34:35] op_sel:[1,1,0] op_sel_hi:[1,0,1] neg_lo:[1,0,0]
    v_cvt_pk_bf16_f32 v41, v34, v35
    ds_write2_b32 v46, v40, v41 offset0:0 offset1:68
    v_pk_mul_f32 v[32:33], v[34:35], v[24:25] op_sel:[0,0] op_sel_hi:[0,1]
    v_pk_fma_f32 v[32:33], v[34:35], v[24:25], v[32:33] op_sel:[1,1,0] op_sel_hi:[1,0,1] neg_lo:[1,0,0]
    v_cvt_pk_bf16_f32 v42, v32, v33
    v_pk_mul_f32 v[34:35], v[32:33], v[24:25] op_sel:[0,0] op_sel_hi:[0,1]
    v_pk_fma_f32 v[34:35], v[32:33], v[24:25], v[34:35] op_sel:[1,1,0] op_sel_hi:[1,0,1] neg_lo:[1,0,0]
    v_cvt_pk_bf16_f32 v43, v34, v35
    ds_write2_b32 v46, v42, v43 offset0:136 offset1:204
    v_pk_mul_f32 v[32:33], v[34:35], v[24:25] op_sel:[0,0] op_sel_hi:[0,1]
    v_pk_fma_f32 v[32:33], v[34:35], v[24:25], v[32:33] op_sel:[1,1,0] op_sel_hi:[1,0,1] neg_lo:[1,0,0]
    v_cvt_pk_bf16_f32 v40, v32, v33
    v_pk_mul_f32 v[34:35], v[32:33], v[24:25] op_sel:[0,0] op_sel_hi:[0,1]
    v_pk_fma_f32 v[34:35], v[32:33], v[24:25], v[34:35] op_sel:[1,1,0] op_sel_hi:[1,0,1] neg_lo:[1,0,0]
    v_cvt_pk_bf16_f32 v41, v34, v35
    ds_write2_b32 v47, v40, v41 offset0:0 offset1:68
    v_pk_mul_f32 v[32:33], v[34:35], v[24:25] op_sel:[0,0] op_sel_hi:[0,1]
    v_pk_fma_f32 v[32:33], v[34:35], v[24:25], v[32:33] op_sel:[1,1,0] op_sel_hi:[1,0,1] neg_lo:[1,0,0]
    v_cvt_pk_bf16_f32 v42, v32, v33
    v_pk_mul_f32 v[34:35], v[32:33], v[24:25] op_sel:[0,0] op_sel_hi:[0,1]
    v_pk_fma_f32 v[34:35], v[32:33], v[24:25], v[34:35] op_sel:[1,1,0] op_sel_hi:[1,0,1] neg_lo:[1,0,0]
    v_cvt_pk_bf16_f32 v43, v34, v35
    ds_write2_b32 v47, v42, v43 offset0:136 offset1:204
    ds_read_b128 a[0:3], v48 offset:0
    ds_read_b128 a[4:7], v48 offset:64
    ds_read_b128 a[8:11], v48 offset:128
    ds_read_b128 a[12:15], v48 offset:192
    v_pk_mul_f32 v[30:31], v[28:29], v[26:27] op_sel:[0,0] op_sel_hi:[0,1]
    v_pk_fma_f32 v[30:31], v[28:29], v[26:27], v[30:31] op_sel:[1,1,0] op_sel_hi:[1,0,1] neg_lo:[1,0,0]
    v_cvt_pk_bf16_f32 v40, v28, -v29
    v_pk_mul_f32 v[32:33], v[28:29], v[18:19] op_sel:[0,0] op_sel_hi:[0,1]
    v_pk_fma_f32 v[32:33], v[28:29], v[18:19], v[32:33] op_sel:[1,1,0] op_sel_hi:[1,0,1] neg_lo:[1,0,0]
    v_cvt_pk_bf16_f32 v41, v32, -v33
    ds_write2_b32 v44, v40, v41 offset0:0 offset1:68
    v_pk_mul_f32 v[34:35], v[32:33], v[18:19] op_sel:[0,0] op_sel_hi:[0,1]
    v_pk_fma_f32 v[34:35], v[32:33], v[18:19], v[34:35] op_sel:[1,1,0] op_sel_hi:[1,0,1] neg_lo:[1,0,0]
    v_cvt_pk_bf16_f32 v42, v34, -v35
    v_pk_mul_f32 v[32:33], v[34:35], v[18:19] op_sel:[0,0] op_sel_hi:[0,1]
    v_pk_fma_f32 v[32:33], v[34:35], v[18:19], v[32:33] op_sel:[1,1,0] op_sel_hi:[1,0,1] neg_lo:[1,0,0]
    v_cvt_pk_bf16_f32 v43, v32, -v33
    ds_write2_b32 v44, v42, v43 offset0:136 offset1:204
    v_pk_mul_f32 v[34:35], v[32:33], v[18:19] op_sel:[0,0] op_sel_hi:[0,1]
    v_pk_fma_f32 v[34:35], v[32:33], v[18:19], v[34:35] op_sel:[1,1,0] op_sel_hi:[1,0,1] neg_lo:[1,0,0]
    v_cvt_pk_bf16_f32 v40, v34, -v35
    v_pk_mul_f32 v[32:33], v[34:35], v[18:19] op_sel:[0,0] op_sel_hi:[0,1]
    v_pk_fma_f32 v[32:33], v[34:35], v[18:19], v[32:33] op_sel:[1,1,0] op_sel_hi:[1,0,1] neg_lo:[1,0,0]
    v_cvt_pk_bf16_f32 v41, v32, -v33
    ds_write2_b32 v45, v40, v41 offset0:0 offset1:68
    v_pk_mul_f32 v[34:35], v[32:33], v[18:19] op_sel:[0,0] op_sel_hi:[0,1]
    v_pk_fma_f32 v[34:35], v[32:33], v[18:19], v[34:35] op_sel:[1,1,0] op_sel_hi:[1,0,1] neg_lo:[1,0,0]
    v_cvt_pk_bf16_f32 v42, v34, -v35
    v_pk_mul_f32 v[32:33], v[34:35], v[18:19] op_sel:[0,0] op_sel_hi:[0,1]
    v_pk_fma_f32 v[32:33], v[34:35], v[18:19], v[32:33] op_sel:[1,1,0] op_sel_hi:[1,0,1] neg_lo:[1,0,0]
    v_cvt_pk_bf16_f32 v43, v32, -v33
    ds_write2_b32 v45, v42, v43 offset0:136 offset1:204
    v_cvt_pk_bf16_f32 v40, v30, -v31
    v_pk_mul_f32 v[32:33], v[30:31], v[18:19] op_sel:[0,0] op_sel_hi:[0,1]
    v_pk_fma_f32 v[32:33], v[30:31], v[18:19], v[32:33] op_sel:[1,1,0] op_sel_hi:[1,0,1] neg_lo:[1,0,0]
    v_cvt_pk_bf16_f32 v41, v32, -v33
    ds_write2_b32 v46, v40, v41 offset0:0 offset1:68
    v_pk_mul_f32 v[34:35], v[32:33], v[18:19] op_sel:[0,0] op_sel_hi:[0,1]
    v_pk_fma_f32 v[34:35], v[32:33], v[18:19], v[34:35] op_sel:[1,1,0] op_sel_hi:[1,0,1] neg_lo:[1,0,0]
    v_cvt_pk_bf16_f32 v42, v34, -v35
    v_pk_mul_f32 v[32:33], v[34:35], v[18:19] op_sel:[0,0] op_sel_hi:[0,1]
    v_pk_fma_f32 v[32:33], v[34:35], v[18:19], v[32:33] op_sel:[1,1,0] op_sel_hi:[1,0,1] neg_lo:[1,0,0]
    v_cvt_pk_bf16_f32 v43, v32, -v33
    ds_write2_b32 v46, v42, v43 offset0:136 offset1:204
    v_pk_mul_f32 v[34:35], v[32:33], v[18:19] op_sel:[0,0] op_sel_hi:[0,1]
    v_pk_fma_f32 v[34:35], v[32:33], v[18:19], v[34:35] op_sel:[1,1,0] op_sel_hi:[1,0,1] neg_lo:[1,0,0]
    v_cvt_pk_bf16_f32 v40, v34, -v35
    v_pk_mul_f32 v[32:33], v[34:35], v[18:19] op_sel:[0,0] op_sel_hi:[0,1]
    v_pk_fma_f32 v[32:33], v[34:35], v[18:19], v[32:33] op_sel:[1,1,0] op_sel_hi:[1,0,1] neg_lo:[1,0,0]
    v_cvt_pk_bf16_f32 v41, v32, -v33
    ds_write2_b32 v47, v40, v41 offset0:0 offset1:68
    v_pk_mul_f32 v[34:35], v[32:33], v[18:19] op_sel:[0,0] op_sel_hi:[0,1]
    v_pk_fma_f32 v[34:35], v[32:33], v[18:19], v[34:35] op_sel:[1,1,0] op_sel_hi:[1,0,1] neg_lo:[1,0,0]
    v_cvt_pk_bf16_f32 v42, v34, -v35
    v_pk_mul_f32 v[32:33], v[34:35], v[18:19] op_sel:[0,0] op_sel_hi:[0,1]
    v_pk_fma_f32 v[32:33], v[34:35], v[18:19], v[32:33] op_sel:[1,1,0] op_sel_hi:[1,0,1] neg_lo:[1,0,0]
    v_cvt_pk_bf16_f32 v43, v32, -v33
    ds_write2_b32 v47, v42, v43 offset0:136 offset1:204
    ds_read_b128 a[16:19], v48 offset:0
    ds_read_b128 a[20:23], v48 offset:64
    ds_read_b128 a[24:27], v48 offset:128
    ds_read_b128 a[28:31], v48 offset:192
    v_pk_mul_f32 v[20:21], v[18:19], v[18:19] op_sel:[0,0] op_sel_hi:[0,1]
    v_pk_fma_f32 v[20:21], v[18:19], v[18:19], v[20:21] op_sel:[1,1,0] op_sel_hi:[1,0,1] neg_lo:[1,0,0]
    v_pk_mul_f32 v[22:23], v[20:21], v[20:21] op_sel:[0,0] op_sel_hi:[0,1]
    v_pk_fma_f32 v[22:23], v[20:21], v[20:21], v[22:23] op_sel:[1,1,0] op_sel_hi:[1,0,1] neg_lo:[1,0,0]
    v_pk_mul_f32 v[28:29], v[30:31], v[26:27] op_sel:[0,0] op_sel_hi:[0,1]
    v_pk_fma_f32 v[28:29], v[30:31], v[26:27], v[28:29] op_sel:[1,1,0] op_sel_hi:[1,0,1] neg_lo:[1,0,0]
    v_pk_mul_f32 v[30:31], v[28:29], v[26:27] op_sel:[0,0] op_sel_hi:[0,1]
    v_pk_fma_f32 v[30:31], v[28:29], v[26:27], v[30:31] op_sel:[1,1,0] op_sel_hi:[1,0,1] neg_lo:[1,0,0]
    v_cvt_pk_bf16_f32 v40, v28, -v29
    v_pk_mul_f32 v[32:33], v[28:29], v[20:21] op_sel:[0,0] op_sel_hi:[0,1]
    v_pk_fma_f32 v[32:33], v[28:29], v[20:21], v[32:33] op_sel:[1,1,0] op_sel_hi:[1,0,1] neg_lo:[1,0,0]
    v_cvt_pk_bf16_f32 v41, v32, -v33
    ds_write2_b32 v44, v40, v41 offset0:0 offset1:68
    v_pk_mul_f32 v[34:35], v[32:33], v[20:21] op_sel:[0,0] op_sel_hi:[0,1]
    v_pk_fma_f32 v[34:35], v[32:33], v[20:21], v[34:35] op_sel:[1,1,0] op_sel_hi:[1,0,1] neg_lo:[1,0,0]
    v_cvt_pk_bf16_f32 v42, v34, -v35
    v_pk_mul_f32 v[32:33], v[34:35], v[20:21] op_sel:[0,0] op_sel_hi:[0,1]
    v_pk_fma_f32 v[32:33], v[34:35], v[20:21], v[32:33] op_sel:[1,1,0] op_sel_hi:[1,0,1] neg_lo:[1,0,0]
    v_cvt_pk_bf16_f32 v43, v32, -v33
    ds_write2_b32 v44, v42, v43 offset0:136 offset1:204
    v_cvt_pk_bf16_f32 v40, v30, -v31
    v_pk_mul_f32 v[32:33], v[30:31], v[20:21] op_sel:[0,0] op_sel_hi:[0,1]
    v_pk_fma_f32 v[32:33], v[30:31], v[20:21], v[32:33] op_sel:[1,1,0] op_sel_hi:[1,0,1] neg_lo:[1,0,0]
    v_cvt_pk_bf16_f32 v41, v32, -v33
    ds_write2_b32 v45, v40, v41 offset0:0 offset1:68
    v_pk_mul_f32 v[34:35], v[32:33], v[20:21] op_sel:[0,0] op_sel_hi:[0,1]
    v_pk_fma_f32 v[34:35], v[32:33], v[20:21], v[34:35] op_sel:[1,1,0] op_sel_hi:[1,0,1] neg_lo:[1,0,0]
    v_cvt_pk_bf16_f32 v42, v34, -v35
    v_pk_mul_f32 v[32:33], v[34:35], v[20:21] op_sel:[0,0] op_sel_hi:[0,1]
    v_pk_fma_f32 v[32:33], v[34:35], v[20:21], v[32:33] op_sel:[1,1,0] op_sel_hi:[1,0,1] neg_lo:[1,0,0]
    v_cvt_pk_bf16_f32 v43, v32, -v33
    ds_write2_b32 v45, v42, v43 offset0:136 offset1:204
    v_pk_mul_f32 v[28:29], v[30:31], v[26:27] op_sel:[0,0] op_sel_hi:[0,1]
    v_pk_fma_f32 v[28:29], v[30:31], v[26:27], v[28:29] op_sel:[1,1,0] op_sel_hi:[1,0,1] neg_lo:[1,0,0]
    v_cvt_pk_bf16_f32 v40, v28, -v29
    v_pk_mul_f32 v[32:33], v[28:29], v[22:23] op_sel:[0,0] op_sel_hi:[0,1]
    v_pk_fma_f32 v[32:33], v[28:29], v[22:23], v[32:33] op_sel:[1,1,0] op_sel_hi:[1,0,1] neg_lo:[1,0,0]
    v_cvt_pk_bf16_f32 v41, v32, -v33
    ds_write2_b32 v46, v40, v41 offset0:0 offset1:68
    v_pk_mul_f32 v[30:31], v[28:29], v[26:27] op_sel:[0,0] op_sel_hi:[0,1]
    v_pk_fma_f32 v[30:31], v[28:29], v[26:27], v[30:31] op_sel:[1,1,0] op_sel_hi:[1,0,1] neg_lo:[1,0,0]
    v_cvt_pk_bf16_f32 v42, v30, -v31
    v_pk_mul_f32 v[32:33], v[30:31], v[22:23] op_sel:[0,0] op_sel_hi:[0,1]
    v_pk_fma_f32 v[32:33], v[30:31], v[22:23], v[32:33] op_sel:[1,1,0] op_sel_hi:[1,0,1] neg_lo:[1,0,0]
    v_cvt_pk_bf16_f32 v43, v32, -v33
    ds_write2_b32 v46, v42, v43 offset0:136 offset1:204
    v_pk_mul_f32 v[28:29], v[30:31], v[26:27] op_sel:[0,0] op_sel_hi:[0,1]
    v_pk_fma_f32 v[28:29], v[30:31], v[26:27], v[28:29] op_sel:[1,1,0] op_sel_hi:[1,0,1] neg_lo:[1,0,0]
    v_cvt_pk_bf16_f32 v40, v28, -v29
    v_pk_mul_f32 v[32:33], v[28:29], v[22:23] op_sel:[0,0] op_sel_hi:[0,1]
    v_pk_fma_f32 v[32:33], v[28:29], v[22:23], v[32:33] op_sel:[1,1,0] op_sel_hi:[1,0,1] neg_lo:[1,0,0]
    v_cvt_pk_bf16_f32 v41, v32, -v33
    ds_write2_b32 v47, v40, v41 offset0:0 offset1:68
    v_pk_mul_f32 v[30:31], v[28:29], v[26:27] op_sel:[0,0] op_sel_hi:[0,1]
    v_pk_fma_f32 v[30:31], v[28:29], v[26:27], v[30:31] op_sel:[1,1,0] op_sel_hi:[1,0,1] neg_lo:[1,0,0]
    v_cvt_pk_bf16_f32 v42, v30, -v31
    v_pk_mul_f32 v[32:33], v[30:31], v[22:23] op_sel:[0,0] op_sel_hi:[0,1]
    v_pk_fma_f32 v[32:33], v[30:31], v[22:23], v[32:33] op_sel:[1,1,0] op_sel_hi:[1,0,1] neg_lo:[1,0,0]
    v_cvt_pk_bf16_f32 v43, v32, -v33
    ds_write2_b32 v47, v42, v43 offset0:136 offset1:204
    ds_read_b128 a[32:35], v48 offset:0
    ds_read_b128 a[36:39], v48 offset:64
    ds_read_b128 a[40:43], v48 offset:128
    ds_read_b128 a[44:47], v48 offset:192
    v_pk_mul_f32 v[28:29], v[30:31], v[26:27] op_sel:[0,0] op_sel_hi:[0,1]
    v_pk_fma_f32 v[28:29], v[30:31], v[26:27], v[28:29] op_sel:[1,1,0] op_sel_hi:[1,0,1] neg_lo:[1,0,0]
    v_cvt_pk_bf16_f32 v40, v28, -v29
    v_pk_mul_f32 v[30:31], v[28:29], v[26:27] op_sel:[0,0] op_sel_hi:[0,1]
    v_pk_fma_f32 v[30:31], v[28:29], v[26:27], v[30:31] op_sel:[1,1,0] op_sel_hi:[1,0,1] neg_lo:[1,0,0]
    v_cvt_pk_bf16_f32 v41, v30, -v31
    ds_write2_b32 v44, v40, v41 offset0:0 offset1:68
    v_pk_mul_f32 v[28:29], v[30:31], v[26:27] op_sel:[0,0] op_sel_hi:[0,1]
    v_pk_fma_f32 v[28:29], v[30:31], v[26:27], v[28:29] op_sel:[1,1,0] op_sel_hi:[1,0,1] neg_lo:[1,0,0]
    v_cvt_pk_bf16_f32 v42, v28, -v29
    v_pk_mul_f32 v[30:31], v[28:29], v[26:27] op_sel:[0,0] op_sel_hi:[0,1]
    v_pk_fma_f32 v[30:31], v[28:29], v[26:27], v[30:31] op_sel:[1,1,0] op_sel_hi:[1,0,1] neg_lo:[1,0,0]
    v_cvt_pk_bf16_f32 v43, v30, -v31
    ds_write2_b32 v44, v42, v43 offset0:136 offset1:204
    v_pk_mul_f32 v[28:29], v[30:31], v[26:27] op_sel:[0,0] op_sel_hi:[0,1]
    v_pk_fma_f32 v[28:29], v[30:31], v[26:27], v[28:29] op_sel:[1,1,0] op_sel_hi:[1,0,1] neg_lo:[1,0,0]
    v_cvt_pk_bf16_f32 v40, v28, -v29
    v_pk_mul_f32 v[30:31], v[28:29], v[26:27] op_sel:[0,0] op_sel_hi:[0,1]
    v_pk_fma_f32 v[30:31], v[28:29], v[26:27], v[30:31] op_sel:[1,1,0] op_sel_hi:[1,0,1] neg_lo:[1,0,0]
    v_cvt_pk_bf16_f32 v41, v30, -v31
    ds_write2_b32 v45, v40, v41 offset0:0 offset1:68
    v_pk_mul_f32 v[28:29], v[30:31], v[26:27] op_sel:[0,0] op_sel_hi:[0,1]
    v_pk_fma_f32 v[28:29], v[30:31], v[26:27], v[28:29] op_sel:[1,1,0] op_sel_hi:[1,0,1] neg_lo:[1,0,0]
    v_cvt_pk_bf16_f32 v42, v28, -v29
    v_pk_mul_f32 v[30:31], v[28:29], v[26:27] op_sel:[0,0] op_sel_hi:[0,1]
    v_pk_fma_f32 v[30:31], v[28:29], v[26:27], v[30:31] op_sel:[1,1,0] op_sel_hi:[1,0,1] neg_lo:[1,0,0]
    v_cvt_pk_bf16_f32 v43, v30, -v31
    ds_write2_b32 v45, v42, v43 offset0:136 offset1:204
    v_pk_mul_f32 v[28:29], v[30:31], v[26:27] op_sel:[0,0] op_sel_hi:[0,1]
    v_pk_fma_f32 v[28:29], v[30:31], v[26:27], v[28:29] op_sel:[1,1,0] op_sel_hi:[1,0,1] neg_lo:[1,0,0]
    v_cvt_pk_bf16_f32 v40, v28, -v29
    v_cvt_pk_bf16_f32 v41, v28, -v29
    ds_write2_b32 v46, v40, v41 offset0:0 offset1:68
    ds_read_b128 a[48:51], v48 offset:0
    ds_read_b128 a[52:55], v48 offset:64
    ds_read_b128 a[56:59], v48 offset:128
    ds_read_b128 a[60:63], v48 offset:192
    s_waitcnt lgkmcnt(15)
    v_mfma_f32_16x16x32_bf16 a[64:67], a[16:19], a[0:3], a[64:67]
    v_lshlrev_b32 v12, 16, v0
    v_lshlrev_b32 v13, 16, v2
    v_lshlrev_b32 v14, 16, v4
    v_mfma_f32_16x16x32_bf16 a[64:67], a[20:23], a[4:7], a[64:67]
    v_lshlrev_b32 v15, 16, v6
    v_lshlrev_b32 v16, 16, v8
    v_lshlrev_b32 v17, 16, v10
    v_mfma_f32_16x16x32_bf16 a[64:67], a[24:27], a[8:11], a[64:67]
    v_alignbit_b32 v0, v1, v0, 16
    v_alignbit_b32 v2, v3, v2, 16
    v_alignbit_b32 v4, v5, v4, 16
    v_mfma_f32_16x16x32_bf16 a[64:67], a[28:31], a[12:15], a[64:67]
    v_alignbit_b32 v6, v7, v6, 16
    v_alignbit_b32 v8, v9, v8, 16
    v_alignbit_b32 v10, v11, v10, 16
    s_waitcnt lgkmcnt(9)
    v_mfma_f32_16x16x32_bf16 a[68:71], a[32:35], a[0:3], a[68:71]
    v_mul_f32 v12, s64, v12
    v_mul_f32 v13, s64, v13
    v_mul_f32 v14, s64, v14
    v_mfma_f32_16x16x32_bf16 a[68:71], a[36:39], a[4:7], a[68:71]
    v_mul_f32 v15, s64, v15
    v_mul_f32 v28, v16, v14
    v_mul_f32 v29, v16, v15
    v_mfma_f32_16x16x32_bf16 a[68:71], a[40:43], a[8:11], a[68:71]
    v_fma_f32 v28, -v17, v15, v28
    v_fmac_f32 v29, v17, v14
    v_mul_f32 v36, s65, v12
    v_mfma_f32_16x16x32_bf16 a[68:71], a[44:47], a[12:15], a[68:71]
    v_mul_f32 v37, s66, v13
    v_fma_f32 v38, v13, s66, -v37
    v_fmac_f32 v38, 0x31dc9c88, v13
    s_waitcnt lgkmcnt(0)
    v_mfma_f32_16x16x32_bf16 a[72:75], a[0:3], a[48:51], a[72:75]
    v_mul_f32 v12, 0x41000000, v37
    v_mul_f32 v13, 0x41000000, v36
    v_fract_f32 v12, v12
    v_mfma_f32_16x16x32_bf16 a[72:75], a[4:7], a[52:55], a[72:75]
    v_fmac_f32 v12, 0x41000000, v38
    v_exp_f32 v13, v13
    v_cos_f32 v24, v12
    v_mfma_f32_16x16x32_bf16 a[72:75], a[8:11], a[56:59], a[72:75]
    v_sin_f32 v25, v12
    v_fract_f32 v14, v37
    v_add_f32 v14, v14, v38
    v_mfma_f32_16x16x32_bf16 a[72:75], a[12:15], a[60:63], a[72:75]
    v_exp_f32 v15, v36
    v_cos_f32 v18, v14
    v_sin_f32 v19, v14
    v_mul_f32 v16, 0x43000000, v37
    v_mul_f32 v17, 0x43000000, v36
    v_fract_f32 v16, v16
    v_fmac_f32 v16, 0x43000000, v38
    v_exp_f32 v17, v17
    v_cos_f32 v26, v16
    v_sin_f32 v27, v16
    v_mul_f32 v24, v24, v13
    v_mul_f32 v25, v25, v13
    v_mul_f32 v18, v18, v15
    v_mul_f32 v19, v19, v15
    v_mul_f32 v26, v26, v17
    v_mul_f32 v27, v27, v17
    s_add_u32 s67, s67, 1
    s_cmp_lt_u32 s67, 3
    s_nop 2
    s_cbranch_scc1 L_kgen_loop
    s_lshl_b32 s72, s3, 2
    s_add_u32 s72, s72, 163536
    v_mov_b32 v124, s72
    ds_write_b32 v124, v124
    s_lshl_b32 s67, s3, 10
    s_add_u32 s67, s67, 135936
    s_add_u32 s68, s68, 16
    v_accvgpr_read_b32 v8, a64
    v_accvgpr_read_b32 v9, a65
    v_accvgpr_read_b32 v10, a66
    v_accvgpr_read_b32 v11, a67
    v_accvgpr_read_b32 v12, a68
    v_accvgpr_read_b32 v13, a69
    v_accvgpr_read_b32 v14, a70
    v_accvgpr_read_b32 v15, a71
    v_accvgpr_read_b32 v16, a72
    v_accvgpr_read_b32 v17, a73
    v_accvgpr_read_b32 v18, a74
    v_accvgpr_read_b32 v19, a75
    v_cvt_pk_bf16_f32 v20, v8, v9
    v_cvt_pk_bf16_f32 v21, v10, v11
    v_cvt_pk_bf16_f32 v22, v12, v13
    v_cvt_pk_bf16_f32 v23, v14, v15
    v_cvt_pk_bf16_f32 v24, v16, v17
    v_cvt_pk_bf16_f32 v25, v18, v19
    v_lshlrev_b32 v2, 7, v105
    v_add_u32 v2, s67, v2
    v_lshrrev_b32 v3, 1, v105
    v_sub_u32 v4, 3, v3
    v_lshlrev_b32 v4, v4, v104
    v_add_u32 v4, v4, v2
    v_mul_u32_u24 v5, 60, v3
    v_add_u32 v5, v4, v5
    ds_write_b32 v4, v22
    ds_write_b32 v5, v23 offset:4
    v_lshlrev_b32 v2, 5, v104
    v_lshl_add_u32 v2, v105, 3, v2
    v_add_u32 v2, s67, v2
    ds_write_b64 v2, v[24:25] offset:512
    v_lshl_add_u32 v6, v127, 2, s67
    ds_read2_b32 v[32:33], v6 offset0:0 offset1:1
    ds_read2_b32 v[34:35], v6 offset0:64 offset1:65
    ds_read2_b32 v[36:37], v6 offset0:128 offset1:129
    v_and_b32 v2, 1, v105
    v_lshlrev_b32 v2, 3, v2
    v_lshl_add_u32 v2, v104, 4, v2
    v_lshl_add_u32 v2, v3, 8, v2
    v_add_u32 v2, s68, v2
    ds_write_b64 v2, v[20:21]
    v_mov_b32 v28, 0
    v_mov_b32 v29, 0
    s_sub_u32 s7, s68, 8
    v_mov_b32 v7, s7
    ds_write_b64 v7, v[28:29]
    v_add_u32 v72, s68, v126
    v_subrev_u32 v73, 8, v72
    s_mov_b32 s69, 0x01000100
    s_mov_b32 s75, 0x03020302
    v_lshl_add_u32 v4, v127, 3, s68
    v_lshl_add_u32 v5, v127, 5, s68
    s_waitcnt lgkmcnt(2)
    v_perm_b32 v40, v32, v32, s69
    v_alignbit_b32 v41, v33, v32, 16
    ds_write_b64 v4, v[40:41] offset:512
    v_perm_b32 v44, v34, v34, s69
    v_mov_b32 v45, v34
    v_perm_b32 v46, v34, v34, s75
    v_perm_b32 v47, v35, v35, s69
    ds_write_b128 v72, v[44:47] offset:1024
    v_perm_b32 v8, v36, v36, s69
    v_mov_b32 v9, v8
    v_mov_b32 v10, v36
    v_perm_b32 v11, v36, v36, s75
    v_mov_b32 v12, v11
    v_mov_b32 v13, v11
    v_perm_b32 v14, v37, v37, s69
    v_mov_b32 v15, v14
    ds_write_b128 v5, v[8:11] offset:2048
    ds_write_b128 v5, v[12:15] offset:2064
    ds_read_b64 v[64:65], v73 offset:0
    ds_read_b128 v[48:51], v72 offset:0
    ds_read_b64 v[66:67], v73 offset:1024
    ds_read_b128 v[52:55], v72 offset:1024
    ds_read_b64 v[68:69], v73 offset:2048
    ds_read_b128 v[56:59], v72 offset:2048
    ds_read_b64 v[70:71], v73 offset:3072
    ds_read_b128 v[60:63], v72 offset:3072
    s_waitcnt lgkmcnt(6)
    v_alignbit_b32 v0, v65, v64, 16
    v_alignbit_b32 v1, v48, v65, 16
    v_alignbit_b32 v2, v49, v48, 16
    v_alignbit_b32 v3, v50, v49, 16
    v_mov_b32 v16, v65
    v_mov_b32 v17, v48
    v_mov_b32 v18, v49
    v_mov_b32 v19, v50
    v_alignbit_b32 v32, v48, v65, 16
    v_alignbit_b32 v33, v49, v48, 16
    v_alignbit_b32 v34, v50, v49, 16
    v_alignbit_b32 v35, v51, v50, 16
    s_waitcnt lgkmcnt(4)
    v_alignbit_b32 v4, v67, v66, 16
    v_alignbit_b32 v5, v52, v67, 16
    v_alignbit_b32 v6, v53, v52, 16
    v_alignbit_b32 v7, v54, v53, 16
    v_mov_b32 v20, v67
    v_mov_b32 v21, v52
    v_mov_b32 v22, v53
    v_mov_b32 v23, v54
    v_alignbit_b32 v36, v52, v67, 16
    v_alignbit_b32 v37, v53, v52, 16
    v_alignbit_b32 v38, v54, v53, 16
    v_alignbit_b32 v39, v55, v54, 16
    s_waitcnt lgkmcnt(2)
    v_alignbit_b32 v8, v69, v68, 16
    v_alignbit_b32 v9, v56, v69, 16
    v_alignbit_b32 v10, v57, v56, 16
    v_alignbit_b32 v11, v58, v57, 16
    v_mov_b32 v24, v69
    v_mov_b32 v25, v56
    v_mov_b32 v26, v57
    v_mov_b32 v27, v58
    v_alignbit_b32 v40, v56, v69, 16
    v_alignbit_b32 v41, v57, v56, 16
    v_alignbit_b32 v42, v58, v57, 16
    v_alignbit_b32 v43, v59, v58, 16
    s_waitcnt lgkmcnt(0)
    v_alignbit_b32 v12, v71, v70, 16
    v_alignbit_b32 v13, v60, v71, 16
    v_alignbit_b32 v14, v61, v60, 16
    v_alignbit_b32 v15, v62, v61, 16
    v_mov_b32 v28, v71
    v_mov_b32 v29, v60
    v_mov_b32 v30, v61
    v_mov_b32 v31, v62
    v_alignbit_b32 v44, v60, v71, 16
    v_alignbit_b32 v45, v61, v60, 16
    v_alignbit_b32 v46, v62, v61, 16
    v_alignbit_b32 v47, v63, v62, 16
    s_branch L_kdone
L_agent:
    s_lshl_b32 s72, s3, 2
    s_add_u32 s72, s72, 163536
    v_mov_b32 v124, s72
    ds_write_b32 v124, v124
    s_add_u32 s10, s51, 6
    s_sub_u32 s7, s10, 12
    s_cmp_ge_u32 s10, 12
    s_cselect_b32 s10, s7, s10
    s_sub_u32 s7, s10, 12
    s_cmp_ge_u32 s10, 12
    s_cselect_b32 s10, s7, s10
    s_lshl_b32 s10, s10, 10
    s_add_u32 s11, s10, 1024
    s_cmp_ge_u32 s11, 12288
    s_cselect_b32 s11, 0, s11
    s_add_u32 s12, s11, 1024
    s_cmp_ge_u32 s12, 12288
    s_cselect_b32 s12, 0, s12
    s_add_u32 s13, s12, 1024
    s_cmp_ge_u32 s13, 12288
    s_cselect_b32 s13, 0, s13
    s_add_u32 s14, s13, 1024
    s_cmp_ge_u32 s14, 12288
    s_cselect_b32 s14, 0, s14
    s_add_u32 s15, s14, 1024
    s_cmp_ge_u32 s15, 12288
    s_cselect_b32 s15, 0, s15
    s_mul_i32 s71, s63, 240
    s_mul_i32 s7, s3, 12
    s_add_u32 s71, s71, s7
    s_lshl_b32 s71, s71, 10
    s_add_u32 s71, s71, 5242880
    v_add_u32 v119, s71, v126
    s_mul_i32 s71, s3, 12288
    s_add_u32 s71, s71, 7340032
    s_add_u32 s16, s3, 1
    s_and_b32 s16, s16, 3
    s_lshl_b32 s70, s62, 2
    s_add_u32 s70, s70, s16
    s_mul_i32 s70, s70, 49152
    s_add_u32 s22, s70, s71
    s_add_u32 s17, s3, 2
    s_and_b32 s17, s17, 3
    s_lshl_b32 s70, s62, 2
    s_add_u32 s70, s70, s17
    s_mul_i32 s70, s70, 49152
    s_add_u32 s23, s70, s71
    s_add_u32 s18, s3, 3
    s_and_b32 s18, s18, 3
    s_lshl_b32 s70, s62, 2
    s_add_u32 s70, s70, s18
    s_mul_i32 s70, s70, 49152
    s_add_u32 s24, s70, s71
    s_add_u32 s19, s3, 4
    s_and_b32 s19, s19, 3
    s_lshl_b32 s70, s62, 2
    s_add_u32 s70, s70, s19
    s_mul_i32 s70, s70, 49152
    s_add_u32 s25, s70, s71
    s_mul_i32 s74, s3, 22784
    v_and_b32 v104, 15, v127
    v_lshrrev_b32 v105, 4, v127
    v_and_b32 v106, 3, v127
    v_lshrrev_b32 v107, 2, v127
    v_mul_u32_u24 v111, 10240, v107
    v_lshl_add_u32 v111, v106, 4, v111
    s_mul_i32 s7, s3, 655360
    s_lshl_b32 s71, s40, 4
    s_add_u32 s7, s7, s71
    s_add_u32 s7, s7, 2621440
    v_add_u32 v111, s7, v111
    v_mul_u32_u24 v118, 22784, v106
    v_lshlrev_b32 v107, 4, v107
    v_sub_u32 v118, v118, v107
    s_lshl_b32 s7, s3, 10
    s_sub_u32 s7, 21872, s7
    v_add_u32 v118, s7, v118
    v_mul_u32_u24 v112, 4640, v106
    v_lshrrev_b32 v107, 2, v104
    v_lshl_add_u32 v112, v107, 7, v112
    v_lshl_add_u32 v112, v105, 4, v112
    v_add_u32 v112, s74, v112
    v_lshlrev_b32 v113, 3, v104
    v_sub_u32 v113, s74, v113
    v_lshl_add_u32 v113, v105, 4, v113
    v_add_u32 v113, 18680, v113
    v_lshlrev_b32 v114, 3, v127
    v_sub_u32 v115, s74, v114
    v_add_u32 v115, 19064, v115
    v_add_u32 v116, s74, v126
    v_lshrrev_b32 v117, 5, v127
    v_mul_u32_u24 v117, 4128, v117
    v_add_u32 v117, v117, v116
    v_min_u32 v8, 59, v127
    s_mul_i32 s7, s2, 7680
    v_lshl_add_u32 v8, v8, 7, s7
    global_load_dword v90, v8, s[28:29]
    s_min_u32 s69, s2, 239
    s_mul_i32 s70, s69, 1366
    s_lshr_b32 s70, s70, 16
    s_mul_i32 s75, s70, 48
    s_sub_u32 s75, s69, s75
    v_lshrrev_b32 v11, 4, v127
    v_and_b32 v12, 15, v127
    s_mul_i32 s65, s75, 40960
    s_lshl_b32 s7, s70, 8
    s_add_u32 s65, s65, s7
    v_mul_u32_u24 v13, 1280, v11
    v_lshl_add_u32 v13, v12, 4, v13
    v_add_u32 v13, s65, v13
    global_load_dwordx4 v[16:19], v13, s[32:33]
    v_add_u32 v13, 5120, v13
    global_load_dwordx4 v[20:23], v13, s[32:33]
    v_add_u32 v13, 5120, v13
    global_load_dwordx4 v[24:27], v13, s[32:33]
    v_add_u32 v13, 5120, v13
    global_load_dwordx4 v[28:31], v13, s[32:33]
    v_add_u32 v13, 5120, v13
    global_load_dwordx4 v[32:35], v13, s[32:33]
    v_add_u32 v13, 5120, v13
    global_load_dwordx4 v[36:39], v13, s[32:33]
    v_add_u32 v13, 5120, v13
    global_load_dwordx4 v[40:43], v13, s[32:33]
    v_add_u32 v13, 5120, v13
    global_load_dwordx4 v[44:47], v13, s[32:33]
    v_mul_u32_u24 v14, 288, v11
    v_lshl_add_u32 v14, v12, 4, v14
    v_add_u32 v14, 149760, v14
    v_lshrrev_b32 v15, 5, v127
    v_lshlrev_b32 v15, 4, v15
    v_bfe_u32 v8, v127, 2, 3
    v_add_u32 v15, v15, v8
    v_mul_u32_u24 v15, 288, v15
    v_and_b32 v8, 3, v127
    v_lshl_add_u32 v15, v8, 3, v15
    v_add_u32 v15, 149760, v15
    s_mul_i32 s76, s70, 384
    s_add_u32 s76, s76, s75
    s_lshl_b32 s76, s76, 10
    s_add_u32 s76, s76, 5242880
    s_cmp_lt_u32 s2, 240
    s_cselect_b32 s76, s76, 1879048192
    s_lshr_b32 s7, s2, 2
    s_lshl_b32 s7, s7, 7
    s_and_b32 s79, s2, 3
    s_lshl_b32 s79, s79, 2
    s_add_u32 s79, s79, s7
    s_add_u32 s79, s79, 16351232
    v_add_u32 v8, 0, v127
    v_mul_u32_u24 v9, 5462, v8
    v_lshrrev_b32 v9, 16, v9
    v_mul_u32_u24 v10, 12, v9
    v_sub_u32 v10, v8, v10
    v_mul_u32_u24 v9, 3072, v9
    v_lshl_add_u32 v4, v10, 4, v9
    v_add_u32 v8, 64, v127
    v_mul_u32_u24 v9, 5462, v8
    v_lshrrev_b32 v9, 16, v9
    v_mul_u32_u24 v10, 12, v9
    v_sub_u32 v10, v8, v10
    v_mul_u32_u24 v9, 3072, v9
    v_lshl_add_u32 v5, v10, 4, v9
    v_subrev_u32 v5, 1024, v5
    v_add_u32 v8, 128, v127
    v_mul_u32_u24 v9, 5462, v8
    v_lshrrev_b32 v9, 16, v9
    v_mul_u32_u24 v10, 12, v9
    v_sub_u32 v10, v8, v10
    v_mul_u32_u24 v9, 3072, v9
    v_lshl_add_u32 v6, v10, 4, v9
    v_subrev_u32 v6, 2048, v6
    s_mov_b32 s64, 0
    s_mul_i32 s67, s77, 49152
    s_mul_i32 s68, s5, 192
    s_add_u32 s67, s67, s68
    s_mov_b32 s52, s28
    s_mov_b32 s53, s29
    s_mov_b32 s54, 1966080
    s_mov_b32 s55, 0x20000
    s_mov_b32 s66, 3
L_dma25:
    s_mov_b32 m0, s64
    s_add_u32 s64, s64, 3072
    buffer_load_dwordx4 v4, s[52:55], s67 offen offset:0 lds
    buffer_load_dwordx4 v5, s[52:55], s67 offen offset:1024 lds
    buffer_load_dwordx4 v6, s[52:55], s67 offen offset:2048 lds
    s_add_u32 s67, s67, 49152
    s_mov_b32 m0, s64
    s_add_u32 s64, s64, 3072
    buffer_load_dwordx4 v4, s[52:55], s67 offen offset:0 lds
    buffer_load_dwordx4 v5, s[52:55], s67 offen offset:1024 lds
    buffer_load_dwordx4 v6, s[52:55], s67 offen offset:2048 lds
    s_add_u32 s67, s67, 49152
    s_cmp_ge_u32 s64, 122880
    s_cselect_b32 s64, 0, s64
    s_cmp_ge_u32 s67, 1966080
    s_cselect_b32 s67, s68, s67
    s_sub_u32 s66, s66, 1
    s_cmp_lg_u32 s66, 0
    s_cbranch_scc1 L_dma25
    s_waitcnt vmcnt(18)
    ds_write_b128 v14, v[16:19] offset:0
    ds_write_b128 v14, v[20:23] offset:1152
    ds_write_b128 v14, v[24:27] offset:2304
    ds_write_b128 v14, v[28:31] offset:3456
    ds_write_b128 v14, v[32:35] offset:4608
    ds_write_b128 v14, v[36:39] offset:5760
    ds_write_b128 v14, v[40:43] offset:6912
    ds_write_b128 v14, v[44:47] offset:8064
    ds_read_b64_tr_b16 v[48:49], v15 offset:0
    ds_read_b64_tr_b16 v[50:51], v15 offset:2304
    ds_read_b64_tr_b16 v[52:53], v15 offset:32
    ds_read_b64_tr_b16 v[54:55], v15 offset:2336
    ds_read_b64_tr_b16 v[56:57], v15 offset:64
    ds_read_b64_tr_b16 v[58:59], v15 offset:2368
    ds_read_b64_tr_b16 v[60:61], v15 offset:96
    ds_read_b64_tr_b16 v[62:63], v15 offset:2400
    ds_read_b64_tr_b16 v[64:65], v15 offset:128
    ds_read_b64_tr_b16 v[66:67], v15 offset:2432
    ds_read_b64_tr_b16 v[68:69], v15 offset:160
    ds_read_b64_tr_b16 v[70:71], v15 offset:2464
    ds_read_b64_tr_b16 v[72:73], v15 offset:192
    ds_read_b64_tr_b16 v[74:75], v15 offset:2496
    ds_read_b64_tr_b16 v[76:77], v15 offset:224
    ds_read_b64_tr_b16 v[78:79], v15 offset:2528
    v_and_b32 v124, 3, v127
    v_lshlrev_b32 v124, 2, v124
    v_add_u32 v124, 163584, v124
    s_mov_b32 s73, 0
L_lw26:
    ds_read_b32 v125, v124
    s_add_u32 s73, s73, 1
    s_waitcnt lgkmcnt(0)
    v_cmp_eq_u32 vcc, 0, v125
    s_nop 1
    s_cbranch_vccz L_lw26_ok
    s_sleep 1
    s_cmp_lt_u32 s73, 3200000
    s_cbranch_scc1 L_lw26
L_lw26_ok:
    s_waitcnt lgkmcnt(14)
    buffer_store_dwordx4 v[48:51], v126, s[44:47], s76 offen sc1
    s_add_u32 s76, s76, 49152
    s_waitcnt lgkmcnt(12)
    buffer_store_dwordx4 v[52:55], v126, s[44:47], s76 offen sc1
    s_add_u32 s76, s76, 49152
    s_waitcnt lgkmcnt(10)
    buffer_store_dwordx4 v[56:59], v126, s[44:47], s76 offen sc1
    s_add_u32 s76, s76, 49152
    s_waitcnt lgkmcnt(8)
    buffer_store_dwordx4 v[60:63], v126, s[44:47], s76 offen sc1
    s_add_u32 s76, s76, 49152
    s_waitcnt lgkmcnt(6)
    buffer_store_dwordx4 v[64:67], v126, s[44:47], s76 offen sc1
    s_add_u32 s76, s76, 49152
    s_waitcnt lgkmcnt(4)
    buffer_store_dwordx4 v[68:71], v126, s[44:47], s76 offen sc1
    s_add_u32 s76, s76, 49152
    s_waitcnt lgkmcnt(2)
    buffer_store_dwordx4 v[72:75], v126, s[44:47], s76 offen sc1
    s_add_u32 s76, s76, 49152
    s_waitcnt lgkmcnt(0)
    buffer_store_dwordx4 v[76:79], v126, s[44:47], s76 offen sc1
    s_mov_b32 s66, 2
L_dma27:
    s_mov_b32 m0, s64
    s_add_u32 s64, s64, 3072
    buffer_load_dwordx4 v4, s[52:55], s67 offen offset:0 lds
    buffer_load_dwordx4 v5, s[52:55], s67 offen offset:1024 lds
    buffer_load_dwordx4 v6, s[52:55], s67 offen offset:2048 lds
    s_add_u32 s67, s67, 49152
    s_mov_b32 m0, s64
    s_add_u32 s64, s64, 3072
    buffer_load_dwordx4 v4, s[52:55], s67 offen offset:0 lds
    buffer_load_dwordx4 v5, s[52:55], s67 offen offset:1024 lds
    buffer_load_dwordx4 v6, s[52:55], s67 offen offset:2048 lds
    s_add_u32 s67, s67, 49152
    s_cmp_ge_u32 s64, 122880
    s_cselect_b32 s64, 0, s64
    s_cmp_ge_u32 s67, 1966080
    s_cselect_b32 s67, s68, s67
    s_sub_u32 s66, s66, 1
    s_cmp_lg_u32 s66, 0
    s_cbranch_scc1 L_dma27
    v_mov_b32 v124, 163328
    s_mov_b32 s73, 0
L_lw28:
    ds_read_b32 v125, v124
    s_add_u32 s73, s73, 1
    s_waitcnt lgkmcnt(0)
    v_cmp_eq_u32 vcc, 0, v125
    s_nop 1
    s_cbranch_vccz L_lw28_ok
    s_sleep 1
    s_cmp_lt_u32 s73, 3200000
    s_cbranch_scc1 L_lw28
L_lw28_ok:
    v_readfirstlane_b32 s60, v125
    s_waitcnt vmcnt(12)
    s_nop 0
    v_mov_b32 v124, s60
    s_mov_b64 exec, 1
    buffer_store_dword v124, v126, s[44:47], s79 offen sc1
    s_mov_b64 exec, -1
    s_mov_b32 s66, 4
L_dma29:
    s_mov_b32 m0, s64
    s_add_u32 s64, s64, 3072
    buffer_load_dwordx4 v4, s[52:55], s67 offen offset:0 lds
    buffer_load_dwordx4 v5, s[52:55], s67 offen offset:1024 lds
    buffer_load_dwordx4 v6, s[52:55], s67 offen offset:2048 lds
    s_add_u32 s67, s67, 49152
    s_mov_b32 m0, s64
    s_add_u32 s64, s64, 3072
    buffer_load_dwordx4 v4, s[52:55], s67 offen offset:0 lds
    buffer_load_dwordx4 v5, s[52:55], s67 offen offset:1024 lds
    buffer_load_dwordx4 v6, s[52:55], s67 offen offset:2048 lds
    s_add_u32 s67, s67, 49152
    s_cmp_ge_u32 s64, 122880
    s_cselect_b32 s64, 0, s64
    s_cmp_ge_u32 s67, 1966080
    s_cselect_b32 s67, s68, s67
    s_sub_u32 s66, s66, 1
    s_cmp_lg_u32 s66, 0
    s_cbranch_scc1 L_dma29
    v_mov_b32 v124, 163352
    ds_write_b32 v124, v124
    s_mov_b32 s66, 1
L_dma30:
    s_mov_b32 m0, s64
    s_add_u32 s64, s64, 3072
    buffer_load_dwordx4 v4, s[52:55], s67 offen offset:0 lds
    buffer_load_dwordx4 v5, s[52:55], s67 offen offset:1024 lds
    buffer_load_dwordx4 v6, s[52:55], s67 offen offset:2048 lds
    s_add_u32 s67, s67, 49152
    s_mov_b32 m0, s64
    s_add_u32 s64, s64, 3072
    buffer_load_dwordx4 v4, s[52:55], s67 offen offset:0 lds
    buffer_load_dwordx4 v5, s[52:55], s67 offen offset:1024 lds
    buffer_load_dwordx4 v6, s[52:55], s67 offen offset:2048 lds
    s_add_u32 s67, s67, 49152
    s_cmp_ge_u32 s64, 122880
    s_cselect_b32 s64, 0, s64
    s_cmp_ge_u32 s67, 1966080
    s_cselect_b32 s67, s68, s67
    s_sub_u32 s66, s66, 1
    s_cmp_lg_u32 s66, 0
    s_cbranch_scc1 L_dma30
    s_waitcnt vmcnt(30)
    v_mov_b32 v124, 163520
    ds_write_b32 v124, v124
    s_mov_b32 s66, 5
L_dma31:
    s_mov_b32 m0, s64
    s_add_u32 s64, s64, 3072
    buffer_load_dwordx4 v4, s[52:55], s67 offen offset:0 lds
    buffer_load_dwordx4 v5, s[52:55], s67 offen offset:1024 lds
    buffer_load_dwordx4 v6, s[52:55], s67 offen offset:2048 lds
    s_add_u32 s67, s67, 49152
    s_mov_b32 m0, s64
    s_add_u32 s64, s64, 3072
    buffer_load_dwordx4 v4, s[52:55], s67 offen offset:0 lds
    buffer_load_dwordx4 v5, s[52:55], s67 offen offset:1024 lds
    buffer_load_dwordx4 v6, s[52:55], s67 offen offset:2048 lds
    s_add_u32 s67, s67, 49152
    s_cmp_ge_u32 s64, 122880
    s_cselect_b32 s64, 0, s64
    s_cmp_ge_u32 s67, 1966080
    s_cselect_b32 s67, s68, s67
    s_sub_u32 s66, s66, 1
    s_cmp_lg_u32 s66, 0
    s_cbranch_scc1 L_dma31
    s_waitcnt vmcnt(30)
    v_mov_b32 v124, 163524
    ds_write_b32 v124, v124
    s_mov_b32 s66, 5
L_dma32:
    s_mov_b32 m0, s64
    s_add_u32 s64, s64, 3072
    buffer_load_dwordx4 v4, s[52:55], s67 offen offset:0 lds
    buffer_load_dwordx4 v5, s[52:55], s67 offen offset:1024 lds
    buffer_load_dwordx4 v6, s[52:55], s67 offen offset:2048 lds
    s_add_u32 s67, s67, 49152
    s_mov_b32 m0, s64
    s_add_u32 s64, s64, 3072
    buffer_load_dwordx4 v4, s[52:55], s67 offen offset:0 lds
    buffer_load_dwordx4 v5, s[52:55], s67 offen offset:1024 lds
    buffer_load_dwordx4 v6, s[52:55], s67 offen offset:2048 lds
    s_add_u32 s67, s67, 49152
    s_cmp_ge_u32 s64, 122880
    s_cselect_b32 s64, 0, s64
    s_cmp_ge_u32 s67, 1966080
    s_cselect_b32 s67, s68, s67
    s_sub_u32 s66, s66, 1
    s_cmp_lg_u32 s66, 0
    s_cbranch_scc1 L_dma32
    s_waitcnt vmcnt(30)
    v_mov_b32 v124, 163528
    ds_write_b32 v124, v124
    s_waitcnt vmcnt(0)
    v_mov_b32 v124, 163532
    ds_write_b32 v124, v124
L_kdone:
    v_mov_b32 v124, 163328
    s_mov_b32 s73, 0
L_lw33:
    ds_read_b32 v125, v124
    s_add_u32 s73, s73, 1
    s_waitcnt lgkmcnt(0)
    v_cmp_eq_u32 vcc, 0, v125
    s_nop 1
    s_cbranch_vccz L_lw33_ok
    s_sleep 1
    s_cmp_lt_u32 s73, 3200000
    s_cbranch_scc1 L_lw33
L_lw33_ok:
    v_readfirstlane_b32 s60, v125
    s_mul_i32 s7, s63, 5
    s_lshr_b32 s70, s7, 3
    s_add_u32 s7, s7, 4
    s_lshr_b32 s7, s7, 3
    s_mul_i32 s70, s70, 1536
    s_mul_i32 s7, s7, 1536
    v_mov_b32 v108, s70
    v_mov_b32 v109, s7
    v_cmp_lt_u32 vcc, 31, v127
    s_nop 1
    v_cndmask_b32 v108, v108, v109, vcc
    v_min_u32 v109, 11, v104
    v_lshl_add_u32 v108, v109, 7, v108
    v_add_u32 v108, 16351232, v108
    s_cmp_lg_u32 s3, 0
    s_cbranch_scc1 L_gate34_w
    s_mov_b32 s73, 0
L_poll35:
    buffer_load_dwordx4 v[120:123], v108, s[44:47], 0 offen sc1
    s_waitcnt vmcnt(0)
L_poll35_c:
    v_xor_b32 v120, s60, v120
    v_xor_b32 v121, s60, v121
    v_xor_b32 v122, s60, v122
    v_xor_b32 v123, s60, v123
    v_or_b32 v120, v120, v121
    v_or3_b32 v120, v120, v122, v123
    v_cmp_ne_u32 vcc, 0, v120
    s_nop 1
    s_cbranch_vccz L_poll35_ok
    s_add_u32 s73, s73, 1
    s_sleep 4
    s_cmp_lt_u32 s73, 50000
    s_cbranch_scc1 L_poll35
L_poll35_ok:
    v_mov_b32 v124, 163332
    ds_write_b32 v124, v124
    s_branch L_gate34_ok
L_gate34_w:
    v_mov_b32 v124, 163332
    s_mov_b32 s73, 0
L_lw36:
    ds_read_b32 v125, v124
    s_add_u32 s73, s73, 1
    s_waitcnt lgkmcnt(0)
    v_cmp_eq_u32 vcc, 0, v125
    s_nop 1
    s_cbranch_vccz L_lw36_ok
    s_sleep 1
    s_cmp_lt_u32 s73, 3200000
    s_cbranch_scc1 L_lw36
L_lw36_ok:
L_gate34_ok:
    s_cmp_eq_u32 s3, 3
    s_cbranch_scc1 L_w2skip
    buffer_load_dwordx4 a[0:3], v119, s[44:47], s10 offen sc1
    s_waitcnt vmcnt(5)
    s_add_u32 s71, s10, 49152
    buffer_load_dwordx4 a[4:7], v119, s[44:47], s71 offen sc1
    s_waitcnt vmcnt(5)
    s_add_u32 s71, s10, 98304
    buffer_load_dwordx4 a[8:11], v119, s[44:47], s71 offen sc1
    s_waitcnt vmcnt(5)
    s_add_u32 s71, s10, 147456
    buffer_load_dwordx4 a[12:15], v119, s[44:47], s71 offen sc1
    s_waitcnt vmcnt(5)
    s_add_u32 s71, s10, 196608
    buffer_load_dwordx4 a[16:19], v119, s[44:47], s71 offen sc1
    s_waitcnt vmcnt(5)
    buffer_load_dwordx4 a[20:23], v119, s[44:47], s11 offen sc1
    s_waitcnt vmcnt(5)
    s_add_u32 s71, s11, 49152
    buffer_load_dwordx4 a[24:27], v119, s[44:47], s71 offen sc1
    s_waitcnt vmcnt(5)
    s_add_u32 s71, s11, 98304
    buffer_load_dwordx4 a[28:31], v119, s[44:47], s71 offen sc1
    s_waitcnt vmcnt(5)
    s_add_u32 s71, s11, 147456
    buffer_load_dwordx4 a[32:35], v119, s[44:47], s71 offen sc1
    s_waitcnt vmcnt(5)
    s_add_u32 s71, s11, 196608
    buffer_load_dwordx4 a[36:39], v119, s[44:47], s71 offen sc1
    s_waitcnt vmcnt(5)
    buffer_load_dwordx4 a[40:43], v119, s[44:47], s12 offen sc1
    s_waitcnt vmcnt(5)
    s_add_u32 s71, s12, 49152
    buffer_load_dwordx4 a[44:47], v119, s[44:47], s71 offen sc1
    s_waitcnt vmcnt(5)
L_w2skip:
    v_lshlrev_b32 v110, 7, v127
    v_add_u32 v110, 16285696, v110
    s_cmp_lg_u32 s3, 3
    s_cbranch_scc1 L_gate37_w
    v_mov_b32 v124, 163336
    s_mov_b32 s73, 0
L_lw38:
    ds_read_b32 v125, v124
    s_add_u32 s73, s73, 1
    s_waitcnt lgkmcnt(0)
    v_cmp_eq_u32 vcc, 0, v125
    s_nop 1
    s_cbranch_vccz L_lw38_ok
    s_sleep 1
    s_cmp_lt_u32 s73, 3200000
    s_cbranch_scc1 L_lw38
L_lw38_ok:
    s_mov_b32 s73, 0
L_poll39:
    buffer_load_dwordx4 v[120:123], v110, s[44:47], 0 offen sc1
    s_waitcnt vmcnt(0)
L_poll39_c:
    v_xor_b32 v120, s60, v120
    v_xor_b32 v121, s60, v121
    v_xor_b32 v122, s60, v122
    v_xor_b32 v123, s60, v123
    v_or_b32 v120, v120, v121
    v_or3_b32 v120, v120, v122, v123
    v_cmp_ne_u32 vcc, 0, v120
    s_nop 1
    s_cbranch_vccz L_poll39_ok
    s_add_u32 s73, s73, 1
    s_sleep 4
    s_cmp_lt_u32 s73, 50000
    s_cbranch_scc1 L_poll39
L_poll39_ok:
    v_mov_b32 v124, 163340
    ds_write_b32 v124, v124
    s_branch L_gate37_ok
L_gate37_w:
    v_mov_b32 v124, 163340
    s_mov_b32 s73, 0
L_lw40:
    ds_read_b32 v125, v124
    s_add_u32 s73, s73, 1
    s_waitcnt lgkmcnt(0)
    v_cmp_eq_u32 vcc, 0, v125
    s_nop 1
    s_cbranch_vccz L_lw40_ok
    s_sleep 1
    s_cmp_lt_u32 s73, 3200000
    s_cbranch_scc1 L_lw40
L_lw40_ok:
L_gate37_ok:
    s_cmp_lg_u32 s2, 0
    s_cbranch_scc1 L_norst
    s_cmp_lg_u32 s3, 3
    s_cbranch_scc1 L_norst
    s_mov_b64 exec, 1
    global_store_dword v126, v126, s[38:39] sc1
    s_mov_b64 exec, -1
L_norst:
    s_mov_b32 s71, 0
    buffer_load_dwordx4 v[80:83], v111, s[44:47], s71 offen sc1
    s_mov_b32 s71, 163840
    buffer_load_dwordx4 v[84:87], v111, s[44:47], s71 offen sc1
    s_mov_b32 s71, 327680
    buffer_load_dwordx4 v[88:91], v111, s[44:47], s71 offen sc1
    s_mov_b32 s71, 491520
    buffer_load_dwordx4 v[92:95], v111, s[44:47], s71 offen sc1
    s_cmp_lg_u32 s3, 3
    s_cbranch_scc1 L_w2skip2
    buffer_load_dwordx4 a[0:3], v119, s[44:47], s10 offen sc1
    s_add_u32 s71, s10, 49152
    buffer_load_dwordx4 a[4:7], v119, s[44:47], s71 offen sc1
    s_add_u32 s71, s10, 98304
    buffer_load_dwordx4 a[8:11], v119, s[44:47], s71 offen sc1
    s_add_u32 s71, s10, 147456
    buffer_load_dwordx4 a[12:15], v119, s[44:47], s71 offen sc1
    s_add_u32 s71, s10, 196608
    buffer_load_dwordx4 a[16:19], v119, s[44:47], s71 offen sc1
    buffer_load_dwordx4 a[20:23], v119, s[44:47], s11 offen sc1
    s_add_u32 s71, s11, 49152
    buffer_load_dwordx4 a[24:27], v119, s[44:47], s71 offen sc1
    s_add_u32 s71, s11, 98304
    buffer_load_dwordx4 a[28:31], v119, s[44:47], s71 offen sc1
    s_add_u32 s71, s11, 147456
    buffer_load_dwordx4 a[32:35], v119, s[44:47], s71 offen sc1
    s_add_u32 s71, s11, 196608
    buffer_load_dwordx4 a[36:39], v119, s[44:47], s71 offen sc1
    buffer_load_dwordx4 a[40:43], v119, s[44:47], s12 offen sc1
    s_add_u32 s71, s12, 49152
    buffer_load_dwordx4 a[44:47], v119, s[44:47], s71 offen sc1
    s_waitcnt vmcnt(12)
L_w2skip2:
    s_add_u32 s71, s12, 98304
    buffer_load_dwordx4 a[48:51], v119, s[44:47], s71 offen sc1
    s_waitcnt vmcnt(5)
    s_add_u32 s71, s12, 147456
    buffer_load_dwordx4 a[52:55], v119, s[44:47], s71 offen sc1
    s_waitcnt vmcnt(5)
    v_mov_b32 v76, 0
    v_mov_b32 v77, 0
    v_mov_b32 v78, 0
    v_mov_b32 v79, 0
    v_and_b32 v124, 3, v127
    v_lshlrev_b32 v124, 2, v124
    v_add_u32 v124, 163376, v124
    s_mov_b32 s73, 0
L_lw41:
    ds_read_b32 v125, v124
    s_add_u32 s73, s73, 1
    s_waitcnt lgkmcnt(0)
    v_cmp_eq_u32 vcc, 0, v125
    s_nop 1
    s_cbranch_vccz L_lw41_ok
    s_sleep 1
    s_cmp_lt_u32 s73, 3200000
    s_cbranch_scc1 L_lw41
L_lw41_ok:
    s_cmp_lt_i32 s61, 0
    s_cbranch_scc1 L_nokw
    ds_write_b128 v116, v[0:3] offset:384
    ds_write_b128 v116, v[4:7] offset:1408
    ds_write_b128 v116, v[8:11] offset:2432
    ds_write_b128 v116, v[12:15] offset:3456
    ds_write_b128 v116, v[16:19] offset:5024
    ds_write_b128 v116, v[20:23] offset:6048
    ds_write_b128 v116, v[24:27] offset:7072
    ds_write_b128 v116, v[28:31] offset:8096
    ds_write_b128 v116, v[32:35] offset:9664
    ds_write_b128 v116, v[36:39] offset:10688
    ds_write_b128 v116, v[40:43] offset:11712
    ds_write_b128 v116, v[44:47] offset:12736
    ds_write_b128 v116, v[48:51] offset:14304
    ds_write_b128 v116, v[52:55] offset:15328
    ds_write_b128 v116, v[56:59] offset:16352
    ds_write_b128 v116, v[60:63] offset:17376
    s_mov_b32 exec_lo, 0xffffff
    s_mov_b32 exec_hi, 0xffffff
    ds_write_b128 v117, v[76:79]
    ds_write_b128 v117, v[76:79] offset:9280
    s_mov_b64 exec, 0xff
    ds_write_b128 v116, v[76:79] offset:22656
    s_mov_b64 exec, -1
L_nokw:
    s_waitcnt vmcnt(2)
    s_mov_b32 exec_lo, 0x77777777
    s_mov_b32 exec_hi, 0x77777777
    ds_write_b128 v118, v[80:83] offset:768
    ds_write_b128 v118, v[84:87] offset:512
    ds_write_b128 v118, v[88:91] offset:256
    ds_write_b128 v118, v[92:95] offset:0
    s_mov_b64 exec, -1
    s_lshl_b32 s72, s3, 2
    s_add_u32 s72, s72, 163408
    v_mov_b32 v124, s72
    ds_write_b32 v124, v124
    s_cmp_lt_i32 s61, 0
    s_cbranch_scc0 L_conv
    s_lshl_b32 s72, s3, 2
    s_add_u32 s72, s72, 163568
    v_mov_b32 v124, s72
    ds_write_b32 v124, v124
    s_cmp_lg_u32 s3, 3
    s_cbranch_scc1 L_idle
    v_subrev_u32 v112, s74, v112
    v_subrev_u32 v113, s74, v113
    v_add_u32 v117, 68352, v126
    v_add_u32 v115, 152576, v126
    v_and_b32 v124, 3, v127
    v_lshlrev_b32 v124, 2, v124
    v_add_u32 v124, 163408, v124
    s_mov_b32 s73, 0
L_lw42:
    ds_read_b32 v125, v124
    s_add_u32 s73, s73, 1
    s_waitcnt lgkmcnt(0)
    v_cmp_eq_u32 vcc, 0, v125
    s_nop 1
    s_cbranch_vccz L_lw42_ok
    s_sleep 1
    s_cmp_lt_u32 s73, 3200000
    s_cbranch_scc1 L_lw42
L_lw42_ok:
    ds_read_b128 v[32:35], v112 offset:384
    ds_read_b64 v[92:93], v113 offset:384
    ds_read_b64 v[94:95], v113 offset:392
    ds_read_b64 v[88:89], v113 offset:896
    ds_read_b64 v[90:91], v113 offset:904
    ds_read_b64 v[84:85], v113 offset:1408
    ds_read_b64 v[86:87], v113 offset:1416
    ds_read_b64 v[80:81], v113 offset:1920
    ds_read_b64 v[82:83], v113 offset:1928
    ds_read_b64 v[76:77], v113 offset:2432
    ds_read_b64 v[78:79], v113 offset:2440
    ds_read_b64 v[72:73], v113 offset:2944
    ds_read_b64 v[74:75], v113 offset:2952
    ds_read_b64 v[68:69], v113 offset:3456
    ds_read_b64 v[70:71], v113 offset:3464
    ds_read_b64 v[64:65], v113 offset:3968
    ds_read_b64 v[66:67], v113 offset:3976
    ds_read_b128 v[36:39], v112 offset:896
    ds_read_b128 v[40:43], v112 offset:1408
    ds_read_b128 v[44:47], v112 offset:1920
    ds_read_b128 v[48:51], v112 offset:2432
    ds_read_b128 v[52:55], v112 offset:2944
    ds_read_b128 v[56:59], v112 offset:3456
    ds_read_b128 v[60:63], v112 offset:3968
    s_lshl_b32 s72, s3, 2
    s_add_u32 s72, s72, 163392
    v_mov_b32 v124, s72
    s_mov_b32 s73, 0
L_lw43:
    ds_read_b32 v125, v124
    s_add_u32 s73, s73, 1
    s_waitcnt lgkmcnt(0)
    v_cmp_eq_u32 vcc, 0, v125
    s_nop 1
    s_cbranch_vccz L_lw43_ok
    s_sleep 1
    s_cmp_lt_u32 s73, 3200000
    s_cbranch_scc1 L_lw43
L_lw43_ok:
    s_setprio 3
    v_mfma_f32_16x16x32_bf16 v[0:3], v[32:35], v[64:67], 0
    ds_read_b64 v[108:109], v113 offset:2496
    v_mfma_f32_16x16x32_bf16 v[4:7], v[32:35], v[68:71], 0
    ds_read_b64 v[110:111], v113 offset:2504
    v_mfma_f32_16x16x32_bf16 v[8:11], v[32:35], v[72:75], 0
    s_add_u32 s71, s12, 196608
    buffer_load_dwordx4 a[56:59], v119, s[44:47], s71 offen sc1
    v_mfma_f32_16x16x32_bf16 v[12:15], v[32:35], v[76:79], 0
    ds_read_b64 v[104:105], v113 offset:3008
    v_mfma_f32_16x16x32_bf16 v[16:19], v[32:35], v[80:83], 0
    ds_read_b64 v[106:107], v113 offset:3016
    v_mfma_f32_16x16x32_bf16 v[20:23], v[32:35], v[84:87], 0
    buffer_load_dwordx4 a[60:63], v119, s[44:47], s13 offen sc1
    v_mfma_f32_16x16x32_bf16 v[24:27], v[32:35], v[88:91], 0
    ds_read_b64 v[100:101], v113 offset:3520
    v_mfma_f32_16x16x32_bf16 v[28:31], v[32:35], v[92:95], 0
    ds_read_b128 v[32:35], v112 offset:448
    v_mfma_f32_16x16x32_bf16 v[4:7], v[36:39], v[64:67], v[4:7]
    ds_read_b64 v[92:93], v113 offset:448
    v_mfma_f32_16x16x32_bf16 v[8:11], v[36:39], v[68:71], v[8:11]
    ds_read_b64 v[94:95], v113 offset:456
    v_mfma_f32_16x16x32_bf16 v[12:15], v[36:39], v[72:75], v[12:15]
    ds_read_b64 v[102:103], v113 offset:3528
    v_mfma_f32_16x16x32_bf16 v[16:19], v[36:39], v[76:79], v[16:19]
    s_add_u32 s71, s13, 49152
    buffer_load_dwordx4 a[64:67], v119, s[44:47], s71 offen sc1
    v_mfma_f32_16x16x32_bf16 v[20:23], v[36:39], v[80:83], v[20:23]
    ds_read_b64 v[96:97], v113 offset:4032
    v_mfma_f32_16x16x32_bf16 v[24:27], v[36:39], v[84:87], v[24:27]
    ds_read_b64 v[98:99], v113 offset:4040
    v_mfma_f32_16x16x32_bf16 v[28:31], v[36:39], v[88:91], v[28:31]
    ds_read_b128 v[36:39], v112 offset:960
    v_mfma_f32_16x16x32_bf16 v[8:11], v[40:43], v[64:67], v[8:11]
    ds_read_b64 v[88:89], v113 offset:960
    v_mfma_f32_16x16x32_bf16 v[12:15], v[40:43], v[68:71], v[12:15]
    ds_read_b64 v[90:91], v113 offset:968
    v_mfma_f32_16x16x32_bf16 v[16:19], v[40:43], v[72:75], v[16:19]
    s_add_u32 s71, s13, 98304
    buffer_load_dwordx4 a[68:71], v119, s[44:47], s71 offen sc1
    v_mfma_f32_16x16x32_bf16 v[20:23], v[40:43], v[76:79], v[20:23]
    s_add_u32 s71, s13, 147456
    buffer_load_dwordx4 a[72:75], v119, s[44:47], s71 offen sc1
    v_mfma_f32_16x16x32_bf16 v[24:27], v[40:43], v[80:83], v[24:27]
    v_mfma_f32_16x16x32_bf16 v[28:31], v[40:43], v[84:87], v[28:31]
    ds_read_b128 v[40:43], v112 offset:1472
    v_mfma_f32_16x16x32_bf16 v[12:15], v[44:47], v[64:67], v[12:15]
    ds_read_b64 v[84:85], v113 offset:1472
    v_mfma_f32_16x16x32_bf16 v[16:19], v[44:47], v[68:71], v[16:19]
    ds_read_b64 v[86:87], v113 offset:1480
    v_mfma_f32_16x16x32_bf16 v[20:23], v[44:47], v[72:75], v[20:23]
    v_mfma_f32_16x16x32_bf16 v[24:27], v[44:47], v[76:79], v[24:27]
    v_mfma_f32_16x16x32_bf16 v[28:31], v[44:47], v[80:83], v[28:31]
    ds_read_b128 v[44:47], v112 offset:1984
    v_mfma_f32_16x16x32_bf16 v[16:19], v[48:51], v[64:67], v[16:19]
    ds_read_b64 v[80:81], v113 offset:1984
    v_mfma_f32_16x16x32_bf16 v[20:23], v[48:51], v[68:71], v[20:23]
    ds_read_b64 v[82:83], v113 offset:1992
    v_mfma_f32_16x16x32_bf16 v[24:27], v[48:51], v[72:75], v[24:27]
    v_mfma_f32_16x16x32_bf16 v[28:31], v[48:51], v[76:79], v[28:31]
    ds_read_b128 v[48:51], v112 offset:2496
    v_mfma_f32_16x16x32_bf16 v[20:23], v[52:55], v[64:67], v[20:23]
    v_mfma_f32_16x16x32_bf16 v[24:27], v[52:55], v[68:71], v[24:27]
    v_mfma_f32_16x16x32_bf16 v[28:31], v[52:55], v[72:75], v[28:31]
    ds_read_b128 v[52:55], v112 offset:3008
    v_mfma_f32_16x16x32_bf16 v[24:27], v[56:59], v[64:67], v[24:27]
    v_mfma_f32_16x16x32_bf16 v[28:31], v[56:59], v[68:71], v[28:31]
    ds_read_b128 v[56:59], v112 offset:3520
    v_mfma_f32_16x16x32_bf16 v[28:31], v[60:63], v[64:67], v[28:31]
    ds_read_b128 v[60:63], v112 offset:4032
    s_waitcnt lgkmcnt(4)
    v_mfma_f32_16x16x32_bf16 v[0:3], v[32:35], v[96:99], v[0:3]
    ds_read_b64 v[76:77], v113 offset:25216
    v_mfma_f32_16x16x32_bf16 v[4:7], v[32:35], v[100:103], v[4:7]
    ds_read_b64 v[78:79], v113 offset:25224
    v_mfma_f32_16x16x32_bf16 v[8:11], v[32:35], v[104:107], v[8:11]
    s_add_u32 s71, s13, 196608
    buffer_load_dwordx4 a[76:79], v119, s[44:47], s71 offen sc1
    v_mfma_f32_16x16x32_bf16 v[12:15], v[32:35], v[108:111], v[12:15]
    ds_read_b64 v[72:73], v113 offset:25728
    v_mfma_f32_16x16x32_bf16 v[16:19], v[32:35], v[80:83], v[16:19]
    ds_read_b64 v[74:75], v113 offset:25736
    v_mfma_f32_16x16x32_bf16 v[20:23], v[32:35], v[84:87], v[20:23]
    buffer_load_dwordx4 a[80:83], v119, s[44:47], s14 offen sc1
    v_mfma_f32_16x16x32_bf16 v[24:27], v[32:35], v[88:91], v[24:27]
    ds_read_b64 v[68:69], v113 offset:26240
    v_mfma_f32_16x16x32_bf16 v[28:31], v[32:35], v[92:95], v[28:31]
    ds_read_b128 v[32:35], v112 offset:23168
    v_mfma_f32_16x16x32_bf16 v[4:7], v[36:39], v[96:99], v[4:7]
    ds_read_b64 v[92:93], v113 offset:23168
    v_mfma_f32_16x16x32_bf16 v[8:11], v[36:39], v[100:103], v[8:11]
    ds_read_b64 v[94:95], v113 offset:23176
    v_mfma_f32_16x16x32_bf16 v[12:15], v[36:39], v[104:107], v[12:15]
    ds_read_b64 v[70:71], v113 offset:26248
    v_mfma_f32_16x16x32_bf16 v[16:19], v[36:39], v[108:111], v[16:19]
    s_add_u32 s71, s14, 49152
    buffer_load_dwordx4 a[84:87], v119, s[44:47], s71 offen sc1
    v_mfma_f32_16x16x32_bf16 v[20:23], v[36:39], v[80:83], v[20:23]
    ds_read_b64 v[64:65], v113 offset:26752
    v_mfma_f32_16x16x32_bf16 v[24:27], v[36:39], v[84:87], v[24:27]
    ds_read_b64 v[66:67], v113 offset:26760
    v_mfma_f32_16x16x32_bf16 v[28:31], v[36:39], v[88:91], v[28:31]
    ds_read_b128 v[36:39], v112 offset:23680
    v_mfma_f32_16x16x32_bf16 v[8:11], v[40:43], v[96:99], v[8:11]
    ds_read_b64 v[88:89], v113 offset:23680
    v_mfma_f32_16x16x32_bf16 v[12:15], v[40:43], v[100:103], v[12:15]
    ds_read_b64 v[90:91], v113 offset:23688
    v_mfma_f32_16x16x32_bf16 v[16:19], v[40:43], v[104:107], v[16:19]
    s_add_u32 s71, s14, 98304
    buffer_load_dwordx4 a[88:91], v119, s[44:47], s71 offen sc1
    v_mfma_f32_16x16x32_bf16 v[20:23], v[40:43], v[108:111], v[20:23]
    s_add_u32 s71, s14, 147456
    buffer_load_dwordx4 a[92:95], v119, s[44:47], s71 offen sc1
    v_mfma_f32_16x16x32_bf16 v[24:27], v[40:43], v[80:83], v[24:27]
    ds_write_b128 v117, v[0:3] offset:0
    v_mfma_f32_16x16x32_bf16 v[28:31], v[40:43], v[84:87], v[28:31]
    ds_read_b128 v[40:43], v112 offset:24192
    v_mfma_f32_16x16x32_bf16 v[12:15], v[44:47], v[96:99], v[12:15]
    ds_read_b64 v[84:85], v113 offset:24192
    v_mfma_f32_16x16x32_bf16 v[16:19], v[44:47], v[100:103], v[16:19]
    ds_read_b64 v[86:87], v113 offset:24200
    v_mfma_f32_16x16x32_bf16 v[20:23], v[44:47], v[104:107], v[20:23]
    ds_write_b128 v117, v[4:7] offset:1024
    v_mfma_f32_16x16x32_bf16 v[24:27], v[44:47], v[108:111], v[24:27]
    ds_write_b128 v117, v[8:11] offset:2048
    v_mfma_f32_16x16x32_bf16 v[28:31], v[44:47], v[80:83], v[28:31]
    ds_read_b128 v[44:47], v112 offset:24704
    s_waitcnt lgkmcnt(15)
    v_mfma_f32_16x16x32_bf16 v[16:19], v[48:51], v[96:99], v[16:19]
    ds_read_b64 v[80:81], v113 offset:24704
    v_mfma_f32_16x16x32_bf16 v[20:23], v[48:51], v[100:103], v[20:23]
    ds_read_b64 v[82:83], v113 offset:24712
    v_mfma_f32_16x16x32_bf16 v[24:27], v[48:51], v[104:107], v[24:27]
    ds_write_b128 v117, v[12:15] offset:3072
    v_mfma_f32_16x16x32_bf16 v[28:31], v[48:51], v[108:111], v[28:31]
    ds_read_b128 v[48:51], v112 offset:25216
    s_waitcnt lgkmcnt(15)
    v_mfma_f32_16x16x32_bf16 v[20:23], v[52:55], v[96:99], v[20:23]
    ds_write_b128 v117, v[16:19] offset:4096
    v_mfma_f32_16x16x32_bf16 v[24:27], v[52:55], v[100:103], v[24:27]
    v_mfma_f32_16x16x32_bf16 v[28:31], v[52:55], v[104:107], v[28:31]
    ds_read_b128 v[52:55], v112 offset:25728
    s_waitcnt lgkmcnt(15)
    v_mfma_f32_16x16x32_bf16 v[24:27], v[56:59], v[96:99], v[24:27]
    s_nop 1
    ds_write_b128 v117, v[20:23] offset:5120
    v_mfma_f32_16x16x32_bf16 v[28:31], v[56:59], v[100:103], v[28:31]
    ds_read_b128 v[56:59], v112 offset:26240
    s_waitcnt lgkmcnt(15)
    v_mfma_f32_16x16x32_bf16 v[28:31], v[60:63], v[96:99], v[28:31]
    ds_read_b128 v[60:63], v112 offset:26752
    ds_write_b128 v117, v[24:27] offset:6144
    s_nop 5
    ds_write_b128 v117, v[28:31] offset:7168
    v_mov_b32 v124, 163552
    ds_write_b32 v124, v124
    v_mov_b32 v124, 163356
    ds_write_b32 v124, v124
    s_waitcnt lgkmcnt(9)
    v_mfma_f32_16x16x32_bf16 v[0:3], v[32:35], v[64:67], 0
    ds_read_b64 v[108:109], v113 offset:25280
    v_mfma_f32_16x16x32_bf16 v[4:7], v[32:35], v[68:71], 0
    ds_read_b64 v[110:111], v113 offset:25288
    v_mfma_f32_16x16x32_bf16 v[8:11], v[32:35], v[72:75], 0
    s_add_u32 s71, s14, 196608
    buffer_load_dwordx4 a[96:99], v119, s[44:47], s71 offen sc1
    v_mfma_f32_16x16x32_bf16 v[12:15], v[32:35], v[76:79], 0
    ds_read_b64 v[104:105], v113 offset:25792
    v_mfma_f32_16x16x32_bf16 v[16:19], v[32:35], v[80:83], 0
    ds_read_b64 v[106:107], v113 offset:25800
    v_mfma_f32_16x16x32_bf16 v[20:23], v[32:35], v[84:87], 0
    buffer_load_dwordx4 a[100:103], v119, s[44:47], s15 offen sc1
    v_mfma_f32_16x16x32_bf16 v[24:27], v[32:35], v[88:91], 0
    ds_read_b64 v[100:101], v113 offset:26304
    v_mfma_f32_16x16x32_bf16 v[28:31], v[32:35], v[92:95], 0
    ds_read_b128 v[32:35], v112 offset:23232
    v_mfma_f32_16x16x32_bf16 v[4:7], v[36:39], v[64:67], v[4:7]
    ds_read_b64 v[92:93], v113 offset:23232
    v_mfma_f32_16x16x32_bf16 v[8:11], v[36:39], v[68:71], v[8:11]
    ds_read_b64 v[94:95], v113 offset:23240
    v_mfma_f32_16x16x32_bf16 v[12:15], v[36:39], v[72:75], v[12:15]
    ds_read_b64 v[102:103], v113 offset:26312
    v_mfma_f32_16x16x32_bf16 v[16:19], v[36:39], v[76:79], v[16:19]
    s_add_u32 s71, s15, 49152
    buffer_load_dwordx4 a[104:107], v119, s[44:47], s71 offen sc1
    v_mfma_f32_16x16x32_bf16 v[20:23], v[36:39], v[80:83], v[20:23]
    ds_read_b64 v[96:97], v113 offset:26816
    v_mfma_f32_16x16x32_bf16 v[24:27], v[36:39], v[84:87], v[24:27]
    ds_read_b64 v[98:99], v113 offset:26824
    v_mfma_f32_16x16x32_bf16 v[28:31], v[36:39], v[88:91], v[28:31]
    ds_read_b128 v[36:39], v112 offset:23744
    v_mfma_f32_16x16x32_bf16 v[8:11], v[40:43], v[64:67], v[8:11]
    ds_read_b64 v[88:89], v113 offset:23744
    v_mfma_f32_16x16x32_bf16 v[12:15], v[40:43], v[68:71], v[12:15]
    ds_read_b64 v[90:91], v113 offset:23752
    v_mfma_f32_16x16x32_bf16 v[16:19], v[40:43], v[72:75], v[16:19]
    s_add_u32 s71, s15, 98304
    buffer_load_dwordx4 a[108:111], v119, s[44:47], s71 offen sc1
    v_mfma_f32_16x16x32_bf16 v[20:23], v[40:43], v[76:79], v[20:23]
    s_add_u32 s71, s15, 147456
    buffer_load_dwordx4 a[112:115], v119, s[44:47], s71 offen sc1
    v_mfma_f32_16x16x32_bf16 v[24:27], v[40:43], v[80:83], v[24:27]
    v_mfma_f32_16x16x32_bf16 v[28:31], v[40:43], v[84:87], v[28:31]
    ds_read_b128 v[40:43], v112 offset:24256
    v_mfma_f32_16x16x32_bf16 v[12:15], v[44:47], v[64:67], v[12:15]
    ds_read_b64 v[84:85], v113 offset:24256
    v_mfma_f32_16x16x32_bf16 v[16:19], v[44:47], v[68:71], v[16:19]
    ds_read_b64 v[86:87], v113 offset:24264
    v_mfma_f32_16x16x32_bf16 v[20:23], v[44:47], v[72:75], v[20:23]
    v_mfma_f32_16x16x32_bf16 v[24:27], v[44:47], v[76:79], v[24:27]
    v_mfma_f32_16x16x32_bf16 v[28:31], v[44:47], v[80:83], v[28:31]
    ds_read_b128 v[44:47], v112 offset:24768
    s_waitcnt lgkmcnt(15)
    v_mfma_f32_16x16x32_bf16 v[16:19], v[48:51], v[64:67], v[16:19]
    ds_read_b64 v[80:81], v113 offset:24768
    v_mfma_f32_16x16x32_bf16 v[20:23], v[48:51], v[68:71], v[20:23]
    ds_read_b64 v[82:83], v113 offset:24776
    v_mfma_f32_16x16x32_bf16 v[24:27], v[48:51], v[72:75], v[24:27]
    v_mfma_f32_16x16x32_bf16 v[28:31], v[48:51], v[76:79], v[28:31]
    ds_read_b128 v[48:51], v112 offset:25280
    s_waitcnt lgkmcnt(15)
    v_mfma_f32_16x16x32_bf16 v[20:23], v[52:55], v[64:67], v[20:23]
    v_mfma_f32_16x16x32_bf16 v[24:27], v[52:55], v[68:71], v[24:27]
    v_mfma_f32_16x16x32_bf16 v[28:31], v[52:55], v[72:75], v[28:31]
    ds_read_b128 v[52:55], v112 offset:25792
    s_waitcnt lgkmcnt(15)
    v_mfma_f32_16x16x32_bf16 v[24:27], v[56:59], v[64:67], v[24:27]
    v_mfma_f32_16x16x32_bf16 v[28:31], v[56:59], v[68:71], v[28:31]
    ds_read_b128 v[56:59], v112 offset:26304
    s_waitcnt lgkmcnt(15)
    v_mfma_f32_16x16x32_bf16 v[28:31], v[60:63], v[64:67], v[28:31]
    ds_read_b128 v[60:63], v112 offset:26816
    s_waitcnt lgkmcnt(4)
    v_mfma_f32_16x16x32_bf16 v[0:3], v[32:35], v[96:99], v[0:3]
    ds_read_b64 v[76:77], v113 offset:48000
    v_mfma_f32_16x16x32_bf16 v[4:7], v[32:35], v[100:103], v[4:7]
    ds_read_b64 v[78:79], v113 offset:48008
    v_mfma_f32_16x16x32_bf16 v[8:11], v[32:35], v[104:107], v[8:11]
    s_add_u32 s71, s15, 196608
    buffer_load_dwordx4 a[116:119], v119, s[44:47], s71 offen sc1
    v_mfma_f32_16x16x32_bf16 v[12:15], v[32:35], v[108:111], v[12:15]
    ds_read_b64 v[72:73], v113 offset:48512
    v_mfma_f32_16x16x32_bf16 v[16:19], v[32:35], v[80:83], v[16:19]
    ds_read_b64 v[74:75], v113 offset:48520
    v_mfma_f32_16x16x32_bf16 v[20:23], v[32:35], v[84:87], v[20:23]
    v_mfma_f32_16x16x32_bf16 v[24:27], v[32:35], v[88:91], v[24:27]
    ds_read_b64 v[68:69], v113 offset:49024
    v_mfma_f32_16x16x32_bf16 v[28:31], v[32:35], v[92:95], v[28:31]
    ds_read_b128 v[32:35], v112 offset:45952
    v_mfma_f32_16x16x32_bf16 v[4:7], v[36:39], v[96:99], v[4:7]
    ds_read_b64 v[92:93], v113 offset:45952
    v_mfma_f32_16x16x32_bf16 v[8:11], v[36:39], v[100:103], v[8:11]
    ds_read_b64 v[94:95], v113 offset:45960
    v_mfma_f32_16x16x32_bf16 v[12:15], v[36:39], v[104:107], v[12:15]
    ds_read_b64 v[70:71], v113 offset:49032
    v_mfma_f32_16x16x32_bf16 v[16:19], v[36:39], v[108:111], v[16:19]
    v_mfma_f32_16x16x32_bf16 v[20:23], v[36:39], v[80:83], v[20:23]
    ds_read_b64 v[64:65], v113 offset:49536
    v_mfma_f32_16x16x32_bf16 v[24:27], v[36:39], v[84:87], v[24:27]
    ds_read_b64 v[66:67], v113 offset:49544
    v_mfma_f32_16x16x32_bf16 v[28:31], v[36:39], v[88:91], v[28:31]
    ds_read_b128 v[36:39], v112 offset:46464
    v_mfma_f32_16x16x32_bf16 v[8:11], v[40:43], v[96:99], v[8:11]
    ds_read_b64 v[88:89], v113 offset:46464
    v_mfma_f32_16x16x32_bf16 v[12:15], v[40:43], v[100:103], v[12:15]
    ds_read_b64 v[90:91], v113 offset:46472
    v_mfma_f32_16x16x32_bf16 v[16:19], v[40:43], v[104:107], v[16:19]
    v_mfma_f32_16x16x32_bf16 v[20:23], v[40:43], v[108:111], v[20:23]
    v_mfma_f32_16x16x32_bf16 v[24:27], v[40:43], v[80:83], v[24:27]
    ds_write_b128 v117, v[0:3] offset:8192
    v_mfma_f32_16x16x32_bf16 v[28:31], v[40:43], v[84:87], v[28:31]
    ds_read_b128 v[40:43], v112 offset:46976
    v_mfma_f32_16x16x32_bf16 v[12:15], v[44:47], v[96:99], v[12:15]
    ds_read_b64 v[84:85], v113 offset:46976
    v_mfma_f32_16x16x32_bf16 v[16:19], v[44:47], v[100:103], v[16:19]
    ds_read_b64 v[86:87], v113 offset:46984
    v_mfma_f32_16x16x32_bf16 v[20:23], v[44:47], v[104:107], v[20:23]
    ds_write_b128 v117, v[4:7] offset:9216
    v_mfma_f32_16x16x32_bf16 v[24:27], v[44:47], v[108:111], v[24:27]
    ds_write_b128 v117, v[8:11] offset:10240
    v_mfma_f32_16x16x32_bf16 v[28:31], v[44:47], v[80:83], v[28:31]
    ds_read_b128 v[44:47], v112 offset:47488
    s_waitcnt lgkmcnt(15)
    v_mfma_f32_16x16x32_bf16 v[16:19], v[48:51], v[96:99], v[16:19]
    ds_read_b64 v[80:81], v113 offset:47488
    v_mfma_f32_16x16x32_bf16 v[20:23], v[48:51], v[100:103], v[20:23]
    ds_read_b64 v[82:83], v113 offset:47496
    v_mfma_f32_16x16x32_bf16 v[24:27], v[48:51], v[104:107], v[24:27]
    ds_write_b128 v117, v[12:15] offset:11264
    v_mfma_f32_16x16x32_bf16 v[28:31], v[48:51], v[108:111], v[28:31]
    ds_read_b128 v[48:51], v112 offset:48000
    s_waitcnt lgkmcnt(15)
    v_mfma_f32_16x16x32_bf16 v[20:23], v[52:55], v[96:99], v[20:23]
    ds_write_b128 v117, v[16:19] offset:12288
    v_mfma_f32_16x16x32_bf16 v[24:27], v[52:55], v[100:103], v[24:27]
    v_mfma_f32_16x16x32_bf16 v[28:31], v[52:55], v[104:107], v[28:31]
    ds_read_b128 v[52:55], v112 offset:48512
    s_waitcnt lgkmcnt(15)
    v_mfma_f32_16x16x32_bf16 v[24:27], v[56:59], v[96:99], v[24:27]
    s_nop 1
    ds_write_b128 v117, v[20:23] offset:13312
    v_mfma_f32_16x16x32_bf16 v[28:31], v[56:59], v[100:103], v[28:31]
    ds_read_b128 v[56:59], v112 offset:49024
    s_waitcnt lgkmcnt(15)
    v_mfma_f32_16x16x32_bf16 v[28:31], v[60:63], v[96:99], v[28:31]
    ds_read_b128 v[60:63], v112 offset:49536
    ds_write_b128 v117, v[24:27] offset:14336
    s_nop 5
    ds_write_b128 v117, v[28:31] offset:15360
    v_mov_b32 v124, 163556
    ds_write_b32 v124, v124
    s_waitcnt lgkmcnt(9)
    v_mfma_f32_16x16x32_bf16 v[0:3], v[32:35], v[64:67], 0
    ds_read_b64 v[108:109], v113 offset:48064
    v_mfma_f32_16x16x32_bf16 v[4:7], v[32:35], v[68:71], 0
    ds_read_b64 v[110:111], v113 offset:48072
    v_mfma_f32_16x16x32_bf16 v[8:11], v[32:35], v[72:75], 0
    v_mfma_f32_16x16x32_bf16 v[12:15], v[32:35], v[76:79], 0
    ds_read_b64 v[104:105], v113 offset:48576
    v_mfma_f32_16x16x32_bf16 v[16:19], v[32:35], v[80:83], 0
    ds_read_b64 v[106:107], v113 offset:48584
    v_mfma_f32_16x16x32_bf16 v[20:23], v[32:35], v[84:87], 0
    v_mfma_f32_16x16x32_bf16 v[24:27], v[32:35], v[88:91], 0
    ds_read_b64 v[100:101], v113 offset:49088
    v_mfma_f32_16x16x32_bf16 v[28:31], v[32:35], v[92:95], 0
    ds_read_b128 v[32:35], v112 offset:46016
    v_mfma_f32_16x16x32_bf16 v[4:7], v[36:39], v[64:67], v[4:7]
    ds_read_b64 v[92:93], v113 offset:46016
    v_mfma_f32_16x16x32_bf16 v[8:11], v[36:39], v[68:71], v[8:11]
    ds_read_b64 v[94:95], v113 offset:46024
    v_mfma_f32_16x16x32_bf16 v[12:15], v[36:39], v[72:75], v[12:15]
    ds_read_b64 v[102:103], v113 offset:49096
    v_mfma_f32_16x16x32_bf16 v[16:19], v[36:39], v[76:79], v[16:19]
    v_mfma_f32_16x16x32_bf16 v[20:23], v[36:39], v[80:83], v[20:23]
    ds_read_b64 v[96:97], v113 offset:49600
    v_mfma_f32_16x16x32_bf16 v[24:27], v[36:39], v[84:87], v[24:27]
    ds_read_b64 v[98:99], v113 offset:49608
    v_mfma_f32_16x16x32_bf16 v[28:31], v[36:39], v[88:91], v[28:31]
    ds_read_b128 v[36:39], v112 offset:46528
    v_mfma_f32_16x16x32_bf16 v[8:11], v[40:43], v[64:67], v[8:11]
    ds_read_b64 v[88:89], v113 offset:46528
    v_mfma_f32_16x16x32_bf16 v[12:15], v[40:43], v[68:71], v[12:15]
    ds_read_b64 v[90:91], v113 offset:46536
    v_mfma_f32_16x16x32_bf16 v[16:19], v[40:43], v[72:75], v[16:19]
    v_mfma_f32_16x16x32_bf16 v[20:23], v[40:43], v[76:79], v[20:23]
    v_mfma_f32_16x16x32_bf16 v[24:27], v[40:43], v[80:83], v[24:27]
    v_mfma_f32_16x16x32_bf16 v[28:31], v[40:43], v[84:87], v[28:31]
    ds_read_b128 v[40:43], v112 offset:47040
    v_mfma_f32_16x16x32_bf16 v[12:15], v[44:47], v[64:67], v[12:15]
    ds_read_b64 v[84:85], v113 offset:47040
    v_mfma_f32_16x16x32_bf16 v[16:19], v[44:47], v[68:71], v[16:19]
    ds_read_b64 v[86:87], v113 offset:47048
    v_mfma_f32_16x16x32_bf16 v[20:23], v[44:47], v[72:75], v[20:23]
    v_mfma_f32_16x16x32_bf16 v[24:27], v[44:47], v[76:79], v[24:27]
    v_mfma_f32_16x16x32_bf16 v[28:31], v[44:47], v[80:83], v[28:31]
    ds_read_b128 v[44:47], v112 offset:47552
    s_waitcnt lgkmcnt(15)
    v_mfma_f32_16x16x32_bf16 v[16:19], v[48:51], v[64:67], v[16:19]
    ds_read_b64 v[80:81], v113 offset:47552
    v_mfma_f32_16x16x32_bf16 v[20:23], v[48:51], v[68:71], v[20:23]
    ds_read_b64 v[82:83], v113 offset:47560
    v_mfma_f32_16x16x32_bf16 v[24:27], v[48:51], v[72:75], v[24:27]
    v_mfma_f32_16x16x32_bf16 v[28:31], v[48:51], v[76:79], v[28:31]
    ds_read_b128 v[48:51], v112 offset:48064
    s_waitcnt lgkmcnt(15)
    v_mfma_f32_16x16x32_bf16 v[20:23], v[52:55], v[64:67], v[20:23]
    v_mfma_f32_16x16x32_bf16 v[24:27], v[52:55], v[68:71], v[24:27]
    v_mfma_f32_16x16x32_bf16 v[28:31], v[52:55], v[72:75], v[28:31]
    ds_read_b128 v[52:55], v112 offset:48576
    s_waitcnt lgkmcnt(15)
    v_mfma_f32_16x16x32_bf16 v[24:27], v[56:59], v[64:67], v[24:27]
    v_mfma_f32_16x16x32_bf16 v[28:31], v[56:59], v[68:71], v[28:31]
    ds_read_b128 v[56:59], v112 offset:49088
    s_waitcnt lgkmcnt(15)
    v_mfma_f32_16x16x32_bf16 v[28:31], v[60:63], v[64:67], v[28:31]
    ds_read_b128 v[60:63], v112 offset:49600
    s_waitcnt lgkmcnt(4)
    v_mfma_f32_16x16x32_bf16 v[0:3], v[32:35], v[96:99], v[0:3]
    v_mfma_f32_16x16x32_bf16 v[4:7], v[32:35], v[100:103], v[4:7]
    v_mfma_f32_16x16x32_bf16 v[8:11], v[32:35], v[104:107], v[8:11]
    v_mfma_f32_16x16x32_bf16 v[12:15], v[32:35], v[108:111], v[12:15]
    v_mfma_f32_16x16x32_bf16 v[16:19], v[32:35], v[80:83], v[16:19]
    v_mfma_f32_16x16x32_bf16 v[20:23], v[32:35], v[84:87], v[20:23]
    v_mfma_f32_16x16x32_bf16 v[24:27], v[32:35], v[88:91], v[24:27]
    v_mfma_f32_16x16x32_bf16 v[28:31], v[32:35], v[92:95], v[28:31]
    v_mfma_f32_16x16x32_bf16 v[4:7], v[36:39], v[96:99], v[4:7]
    ds_write_b128 v115, v[0:3] offset:0
    v_mfma_f32_16x16x32_bf16 v[8:11], v[36:39], v[100:103], v[8:11]
    v_mfma_f32_16x16x32_bf16 v[12:15], v[36:39], v[104:107], v[12:15]
    v_mfma_f32_16x16x32_bf16 v[16:19], v[36:39], v[108:111], v[16:19]
    v_mfma_f32_16x16x32_bf16 v[20:23], v[36:39], v[80:83], v[20:23]
    v_mfma_f32_16x16x32_bf16 v[24:27], v[36:39], v[84:87], v[24:27]
    v_mfma_f32_16x16x32_bf16 v[28:31], v[36:39], v[88:91], v[28:31]
    v_mfma_f32_16x16x32_bf16 v[8:11], v[40:43], v[96:99], v[8:11]
    ds_write_b128 v115, v[4:7] offset:1024
    v_mfma_f32_16x16x32_bf16 v[12:15], v[40:43], v[100:103], v[12:15]
    v_mfma_f32_16x16x32_bf16 v[16:19], v[40:43], v[104:107], v[16:19]
    v_mfma_f32_16x16x32_bf16 v[20:23], v[40:43], v[108:111], v[20:23]
    v_mfma_f32_16x16x32_bf16 v[24:27], v[40:43], v[80:83], v[24:27]
    v_mfma_f32_16x16x32_bf16 v[28:31], v[40:43], v[84:87], v[28:31]
    v_mfma_f32_16x16x32_bf16 v[12:15], v[44:47], v[96:99], v[12:15]
    s_nop 0
    ds_write_b128 v115, v[8:11] offset:2048
    v_mfma_f32_16x16x32_bf16 v[16:19], v[44:47], v[100:103], v[16:19]
    v_mfma_f32_16x16x32_bf16 v[20:23], v[44:47], v[104:107], v[20:23]
    v_mfma_f32_16x16x32_bf16 v[24:27], v[44:47], v[108:111], v[24:27]
    v_mfma_f32_16x16x32_bf16 v[28:31], v[44:47], v[80:83], v[28:31]
    s_waitcnt lgkmcnt(6)
    v_mfma_f32_16x16x32_bf16 v[16:19], v[48:51], v[96:99], v[16:19]
    ds_write_b128 v115, v[12:15] offset:3072
    v_mfma_f32_16x16x32_bf16 v[20:23], v[48:51], v[100:103], v[20:23]
    v_mfma_f32_16x16x32_bf16 v[24:27], v[48:51], v[104:107], v[24:27]
    v_mfma_f32_16x16x32_bf16 v[28:31], v[48:51], v[108:111], v[28:31]
    s_waitcnt lgkmcnt(6)
    v_mfma_f32_16x16x32_bf16 v[20:23], v[52:55], v[96:99], v[20:23]
    s_nop 1
    ds_write_b128 v115, v[16:19] offset:4096
    v_mfma_f32_16x16x32_bf16 v[24:27], v[52:55], v[100:103], v[24:27]
    v_mfma_f32_16x16x32_bf16 v[28:31], v[52:55], v[104:107], v[28:31]
    s_waitcnt lgkmcnt(6)
    v_mfma_f32_16x16x32_bf16 v[24:27], v[56:59], v[96:99], v[24:27]
    s_nop 0
    ds_write_b128 v115, v[20:23] offset:5120
    v_mfma_f32_16x16x32_bf16 v[28:31], v[56:59], v[100:103], v[28:31]
    s_waitcnt lgkmcnt(6)
    v_mfma_f32_16x16x32_bf16 v[28:31], v[60:63], v[96:99], v[28:31]
    s_nop 2
    ds_write_b128 v115, v[24:27] offset:6144
    s_nop 3
    ds_write_b128 v115, v[28:31] offset:7168
    v_mov_b32 v124, 163560
    ds_write_b32 v124, v124
    s_setprio 0
    v_mov_b32 v124, 163344
    s_mov_b32 s73, 0
L_lw44:
    ds_read_b32 v125, v124
    s_add_u32 s73, s73, 1
    s_waitcnt lgkmcnt(0)
    v_cmp_eq_u32 vcc, 0, v125
    s_nop 1
    s_cbranch_vccz L_lw44_ok
    s_sleep 1
    s_cmp_lt_u32 s73, 3200000
    s_cbranch_scc1 L_lw44
L_lw44_ok:
    s_add_u32 s71, s22, s10
    buffer_load_dwordx4 v[40:43], v126, s[44:47], s71 offen sc1
    s_add_u32 s71, s22, s11
    buffer_load_dwordx4 v[44:47], v126, s[44:47], s71 offen sc1
    s_add_u32 s71, s22, s12
    buffer_load_dwordx4 v[48:51], v126, s[44:47], s71 offen sc1
    s_add_u32 s71, s22, s13
    buffer_load_dwordx4 v[52:55], v126, s[44:47], s71 offen sc1
    s_add_u32 s71, s22, s14
    buffer_load_dwordx4 v[56:59], v126, s[44:47], s71 offen sc1
    s_add_u32 s71, s22, s15
    buffer_load_dwordx4 v[60:63], v126, s[44:47], s71 offen sc1
    s_add_u32 s71, s23, s10
    buffer_load_dwordx4 v[64:67], v126, s[44:47], s71 offen sc1
    s_add_u32 s71, s23, s11
    buffer_load_dwordx4 v[68:71], v126, s[44:47], s71 offen sc1
    s_add_u32 s71, s23, s12
    buffer_load_dwordx4 v[72:75], v126, s[44:47], s71 offen sc1
    s_add_u32 s71, s23, s13
    buffer_load_dwordx4 v[76:79], v126, s[44:47], s71 offen sc1
    s_add_u32 s71, s23, s14
    buffer_load_dwordx4 v[80:83], v126, s[44:47], s71 offen sc1
    s_add_u32 s71, s23, s15
    buffer_load_dwordx4 v[84:87], v126, s[44:47], s71 offen sc1
    v_and_b32 v124, 3, v127
    v_lshlrev_b32 v124, 2, v124
    v_add_u32 v124, 163568, v124
    s_mov_b32 s73, 0
L_lw45:
    ds_read_b32 v125, v124
    s_add_u32 s73, s73, 1
    s_waitcnt lgkmcnt(0)
    v_cmp_eq_u32 vcc, 0, v125
    s_nop 1
    s_cbranch_vccz L_lw45_ok
    s_sleep 1
    s_cmp_lt_u32 s73, 3200000
    s_cbranch_scc1 L_lw45
L_lw45_ok:
    s_branch L_conv_done
L_idle:
    s_add_u32 s71, s12, 196608
    buffer_load_dwordx4 a[56:59], v119, s[44:47], s71 offen sc1
    s_waitcnt vmcnt(5)
    buffer_load_dwordx4 a[60:63], v119, s[44:47], s13 offen sc1
    s_waitcnt vmcnt(5)
    s_add_u32 s71, s13, 49152
    buffer_load_dwordx4 a[64:67], v119, s[44:47], s71 offen sc1
    s_waitcnt vmcnt(5)
    s_add_u32 s71, s13, 98304
    buffer_load_dwordx4 a[68:71], v119, s[44:47], s71 offen sc1
    s_waitcnt vmcnt(5)
    s_add_u32 s71, s13, 147456
    buffer_load_dwordx4 a[72:75], v119, s[44:47], s71 offen sc1
    s_waitcnt vmcnt(5)
    s_add_u32 s71, s13, 196608
    buffer_load_dwordx4 a[76:79], v119, s[44:47], s71 offen sc1
    s_waitcnt vmcnt(5)
    buffer_load_dwordx4 a[80:83], v119, s[44:47], s14 offen sc1
    s_waitcnt vmcnt(5)
    s_add_u32 s71, s14, 49152
    buffer_load_dwordx4 a[84:87], v119, s[44:47], s71 offen sc1
    s_waitcnt vmcnt(5)
    s_add_u32 s71, s14, 98304
    buffer_load_dwordx4 a[88:91], v119, s[44:47], s71 offen sc1
    s_waitcnt vmcnt(5)
    s_add_u32 s71, s14, 147456
    buffer_load_dwordx4 a[92:95], v119, s[44:47], s71 offen sc1
    s_waitcnt vmcnt(5)
    s_add_u32 s71, s14, 196608
    buffer_load_dwordx4 a[96:99], v119, s[44:47], s71 offen sc1
    s_waitcnt vmcnt(5)
    buffer_load_dwordx4 a[100:103], v119, s[44:47], s15 offen sc1
    s_waitcnt vmcnt(5)
    s_add_u32 s71, s15, 49152
    buffer_load_dwordx4 a[104:107], v119, s[44:47], s71 offen sc1
    s_waitcnt vmcnt(5)
    s_add_u32 s71, s15, 98304
    buffer_load_dwordx4 a[108:111], v119, s[44:47], s71 offen sc1
    s_waitcnt vmcnt(5)
    s_add_u32 s71, s15, 147456
    buffer_load_dwordx4 a[112:115], v119, s[44:47], s71 offen sc1
    s_waitcnt vmcnt(5)
    s_add_u32 s71, s15, 196608
    buffer_load_dwordx4 a[116:119], v119, s[44:47], s71 offen sc1
    s_waitcnt vmcnt(5)
    v_mov_b32 v124, 163344
    s_mov_b32 s73, 0
L_lw46:
    ds_read_b32 v125, v124
    s_add_u32 s73, s73, 1
    s_waitcnt lgkmcnt(0)
    v_cmp_eq_u32 vcc, 0, v125
    s_nop 1
    s_cbranch_vccz L_lw46_ok
    s_sleep 1
    s_cmp_lt_u32 s73, 3200000
    s_cbranch_scc1 L_lw46
L_lw46_ok:
    s_add_u32 s71, s22, s10
    buffer_load_dwordx4 v[40:43], v126, s[44:47], s71 offen sc1
    s_add_u32 s71, s22, s11
    buffer_load_dwordx4 v[44:47], v126, s[44:47], s71 offen sc1
    s_add_u32 s71, s22, s12
    buffer_load_dwordx4 v[48:51], v126, s[44:47], s71 offen sc1
    s_add_u32 s71, s22, s13
    buffer_load_dwordx4 v[52:55], v126, s[44:47], s71 offen sc1
    s_add_u32 s71, s22, s14
    buffer_load_dwordx4 v[56:59], v126, s[44:47], s71 offen sc1
    s_add_u32 s71, s22, s15
    buffer_load_dwordx4 v[60:63], v126, s[44:47], s71 offen sc1
    s_add_u32 s71, s23, s10
    buffer_load_dwordx4 v[64:67], v126, s[44:47], s71 offen sc1
    s_add_u32 s71, s23, s11
    buffer_load_dwordx4 v[68:71], v126, s[44:47], s71 offen sc1
    s_add_u32 s71, s23, s12
    buffer_load_dwordx4 v[72:75], v126, s[44:47], s71 offen sc1
    s_add_u32 s71, s23, s13
    buffer_load_dwordx4 v[76:79], v126, s[44:47], s71 offen sc1
    s_add_u32 s71, s23, s14
    buffer_load_dwordx4 v[80:83], v126, s[44:47], s71 offen sc1
    s_add_u32 s71, s23, s15
    buffer_load_dwordx4 v[84:87], v126, s[44:47], s71 offen sc1
    s_branch L_conv_done
L_conv:
    s_mov_b32 s65, s43
    s_lshl_b32 s75, s65, 16
    s_lshl_b32 s76, s61, 12
    s_add_u32 s76, s76, 13631488
    s_lshl_b32 s7, s3, 13
    s_add_u32 s7, s7, 68352
    s_cmp_eq_u32 s3, 2
    s_cselect_b32 s7, 152576, s7
    v_add_u32 v117, s7, v126
    v_and_b32 v124, 3, v127
    v_lshlrev_b32 v124, 2, v124
    v_add_u32 v124, 163408, v124
    s_mov_b32 s73, 0
L_lw47:
    ds_read_b32 v125, v124
    s_add_u32 s73, s73, 1
    s_waitcnt lgkmcnt(0)
    v_cmp_eq_u32 vcc, 0, v125
    s_nop 1
    s_cbranch_vccz L_lw47_ok
    s_sleep 1
    s_cmp_lt_u32 s73, 3200000
    s_cbranch_scc1 L_lw47
L_lw47_ok:
    ds_read_b128 v[32:35], v112 offset:0
    ds_read_b64 v[92:93], v113 offset:0
    ds_read_b64 v[94:95], v113 offset:8
    ds_read_b64 v[88:89], v113 offset:512
    ds_read_b64 v[90:91], v113 offset:520
    ds_read_b64 v[84:85], v113 offset:1024
    ds_read_b64 v[86:87], v113 offset:1032
    ds_read_b64 v[80:81], v113 offset:1536
    ds_read_b64 v[82:83], v113 offset:1544
    ds_read_b64 v[76:77], v113 offset:2048
    ds_read_b64 v[78:79], v113 offset:2056
    ds_read_b64 v[72:73], v113 offset:2560
    ds_read_b64 v[74:75], v113 offset:2568
    ds_read_b64 v[68:69], v113 offset:3072
    ds_read_b64 v[70:71], v113 offset:3080
    ds_read_b64 v[64:65], v113 offset:3584
    ds_read_b64 v[66:67], v113 offset:3592
    ds_read_b128 v[36:39], v112 offset:512
    ds_read_b128 v[40:43], v112 offset:1024
    ds_read_b128 v[44:47], v112 offset:1536
    ds_read_b128 v[48:51], v112 offset:2048
    ds_read_b128 v[52:55], v112 offset:2560
    ds_read_b128 v[56:59], v112 offset:3072
    ds_read_b128 v[60:63], v112 offset:3584
    s_lshl_b32 s72, s3, 2
    s_add_u32 s72, s72, 163392
    v_mov_b32 v124, s72
    s_mov_b32 s73, 0
L_lw48:
    ds_read_b32 v125, v124
    s_add_u32 s73, s73, 1
    s_waitcnt lgkmcnt(0)
    v_cmp_eq_u32 vcc, 0, v125
    s_nop 1
    s_cbranch_vccz L_lw48_ok
    s_sleep 1
    s_cmp_lt_u32 s73, 3200000
    s_cbranch_scc1 L_lw48
L_lw48_ok:
    s_setprio 3
    v_mfma_f32_16x16x32_bf16 v[0:3], v[32:35], v[64:67], 0
    ds_read_b64 v[108:109], v113 offset:2112
    v_mfma_f32_16x16x32_bf16 v[4:7], v[32:35], v[68:71], 0
    ds_read_b64 v[110:111], v113 offset:2120
    v_mfma_f32_16x16x32_bf16 v[8:11], v[32:35], v[72:75], 0
    s_add_u32 s71, s12, 196608
    buffer_load_dwordx4 a[56:59], v119, s[44:47], s71 offen sc1
    v_mfma_f32_16x16x32_bf16 v[12:15], v[32:35], v[76:79], 0
    ds_read_b64 v[104:105], v113 offset:2624
    v_mfma_f32_16x16x32_bf16 v[16:19], v[32:35], v[80:83], 0
    ds_read_b64 v[106:107], v113 offset:2632
    v_mfma_f32_16x16x32_bf16 v[20:23], v[32:35], v[84:87], 0
    buffer_load_dwordx4 a[60:63], v119, s[44:47], s13 offen sc1
    v_mfma_f32_16x16x32_bf16 v[24:27], v[32:35], v[88:91], 0
    ds_read_b64 v[100:101], v113 offset:3136
    v_mfma_f32_16x16x32_bf16 v[28:31], v[32:35], v[92:95], 0
    ds_read_b128 v[32:35], v112 offset:64
    v_mfma_f32_16x16x32_bf16 v[4:7], v[36:39], v[64:67], v[4:7]
    ds_read_b64 v[92:93], v113 offset:64
    v_mfma_f32_16x16x32_bf16 v[8:11], v[36:39], v[68:71], v[8:11]
    ds_read_b64 v[94:95], v113 offset:72
    v_mfma_f32_16x16x32_bf16 v[12:15], v[36:39], v[72:75], v[12:15]
    ds_read_b64 v[102:103], v113 offset:3144
    v_mfma_f32_16x16x32_bf16 v[16:19], v[36:39], v[76:79], v[16:19]
    s_add_u32 s71, s13, 49152
    buffer_load_dwordx4 a[64:67], v119, s[44:47], s71 offen sc1
    v_mfma_f32_16x16x32_bf16 v[20:23], v[36:39], v[80:83], v[20:23]
    ds_read_b64 v[96:97], v113 offset:3648
    v_mfma_f32_16x16x32_bf16 v[24:27], v[36:39], v[84:87], v[24:27]
    ds_read_b64 v[98:99], v113 offset:3656
    v_mfma_f32_16x16x32_bf16 v[28:31], v[36:39], v[88:91], v[28:31]
    ds_read_b128 v[36:39], v112 offset:576
    v_mfma_f32_16x16x32_bf16 v[8:11], v[40:43], v[64:67], v[8:11]
    ds_read_b64 v[88:89], v113 offset:576
    v_mfma_f32_16x16x32_bf16 v[12:15], v[40:43], v[68:71], v[12:15]
    ds_read_b64 v[90:91], v113 offset:584
    v_mfma_f32_16x16x32_bf16 v[16:19], v[40:43], v[72:75], v[16:19]
    s_add_u32 s71, s13, 98304
    buffer_load_dwordx4 a[68:71], v119, s[44:47], s71 offen sc1
    v_mfma_f32_16x16x32_bf16 v[20:23], v[40:43], v[76:79], v[20:23]
    s_add_u32 s71, s13, 147456
    buffer_load_dwordx4 a[72:75], v119, s[44:47], s71 offen sc1
    v_mfma_f32_16x16x32_bf16 v[24:27], v[40:43], v[80:83], v[24:27]
    v_mfma_f32_16x16x32_bf16 v[28:31], v[40:43], v[84:87], v[28:31]
    ds_read_b128 v[40:43], v112 offset:1088
    v_mfma_f32_16x16x32_bf16 v[12:15], v[44:47], v[64:67], v[12:15]
    ds_read_b64 v[84:85], v113 offset:1088
    v_mfma_f32_16x16x32_bf16 v[16:19], v[44:47], v[68:71], v[16:19]
    ds_read_b64 v[86:87], v113 offset:1096
    v_mfma_f32_16x16x32_bf16 v[20:23], v[44:47], v[72:75], v[20:23]
    v_mfma_f32_16x16x32_bf16 v[24:27], v[44:47], v[76:79], v[24:27]
    v_mfma_f32_16x16x32_bf16 v[28:31], v[44:47], v[80:83], v[28:31]
    ds_read_b128 v[44:47], v112 offset:1600
    v_mfma_f32_16x16x32_bf16 v[16:19], v[48:51], v[64:67], v[16:19]
    ds_read_b64 v[80:81], v113 offset:1600
    v_mfma_f32_16x16x32_bf16 v[20:23], v[48:51], v[68:71], v[20:23]
    ds_read_b64 v[82:83], v113 offset:1608
    v_mfma_f32_16x16x32_bf16 v[24:27], v[48:51], v[72:75], v[24:27]
    v_mfma_f32_16x16x32_bf16 v[28:31], v[48:51], v[76:79], v[28:31]
    ds_read_b128 v[48:51], v112 offset:2112
    v_mfma_f32_16x16x32_bf16 v[20:23], v[52:55], v[64:67], v[20:23]
    v_mfma_f32_16x16x32_bf16 v[24:27], v[52:55], v[68:71], v[24:27]
    v_mfma_f32_16x16x32_bf16 v[28:31], v[52:55], v[72:75], v[28:31]
    ds_read_b128 v[52:55], v112 offset:2624
    v_mfma_f32_16x16x32_bf16 v[24:27], v[56:59], v[64:67], v[24:27]
    v_mfma_f32_16x16x32_bf16 v[28:31], v[56:59], v[68:71], v[28:31]
    ds_read_b128 v[56:59], v112 offset:3136
    v_mfma_f32_16x16x32_bf16 v[28:31], v[60:63], v[64:67], v[28:31]
    ds_read_b128 v[60:63], v112 offset:3648
    s_waitcnt lgkmcnt(4)
    v_mfma_f32_16x16x32_bf16 v[0:3], v[32:35], v[96:99], v[0:3]
    ds_read_b64 v[76:77], v113 offset:2176
    v_mfma_f32_16x16x32_bf16 v[4:7], v[32:35], v[100:103], v[4:7]
    ds_read_b64 v[78:79], v113 offset:2184
    v_mfma_f32_16x16x32_bf16 v[8:11], v[32:35], v[104:107], v[8:11]
    s_add_u32 s71, s13, 196608
    buffer_load_dwordx4 a[76:79], v119, s[44:47], s71 offen sc1
    v_mfma_f32_16x16x32_bf16 v[12:15], v[32:35], v[108:111], v[12:15]
    ds_read_b64 v[72:73], v113 offset:2688
    v_mfma_f32_16x16x32_bf16 v[16:19], v[32:35], v[80:83], v[16:19]
    ds_read_b64 v[74:75], v113 offset:2696
    v_mfma_f32_16x16x32_bf16 v[20:23], v[32:35], v[84:87], v[20:23]
    buffer_load_dwordx4 a[80:83], v119, s[44:47], s14 offen sc1
    v_mfma_f32_16x16x32_bf16 v[24:27], v[32:35], v[88:91], v[24:27]
    ds_read_b64 v[68:69], v113 offset:3200
    v_mfma_f32_16x16x32_bf16 v[28:31], v[32:35], v[92:95], v[28:31]
    ds_read_b128 v[32:35], v112 offset:128
    v_mfma_f32_16x16x32_bf16 v[4:7], v[36:39], v[96:99], v[4:7]
    ds_read_b64 v[92:93], v113 offset:128
    v_mfma_f32_16x16x32_bf16 v[8:11], v[36:39], v[100:103], v[8:11]
    ds_read_b64 v[94:95], v113 offset:136
    v_mfma_f32_16x16x32_bf16 v[12:15], v[36:39], v[104:107], v[12:15]
    ds_read_b64 v[70:71], v113 offset:3208
    v_mfma_f32_16x16x32_bf16 v[16:19], v[36:39], v[108:111], v[16:19]
    s_add_u32 s71, s14, 49152
    buffer_load_dwordx4 a[84:87], v119, s[44:47], s71 offen sc1
    v_mfma_f32_16x16x32_bf16 v[20:23], v[36:39], v[80:83], v[20:23]
    ds_read_b64 v[64:65], v113 offset:3712
    v_mfma_f32_16x16x32_bf16 v[24:27], v[36:39], v[84:87], v[24:27]
    ds_read_b64 v[66:67], v113 offset:3720
    v_mfma_f32_16x16x32_bf16 v[28:31], v[36:39], v[88:91], v[28:31]
    ds_read_b128 v[36:39], v112 offset:640
    v_mfma_f32_16x16x32_bf16 v[8:11], v[40:43], v[96:99], v[8:11]
    ds_read_b64 v[88:89], v113 offset:640
    v_mfma_f32_16x16x32_bf16 v[12:15], v[40:43], v[100:103], v[12:15]
    ds_read_b64 v[90:91], v113 offset:648
    v_mfma_f32_16x16x32_bf16 v[16:19], v[40:43], v[104:107], v[16:19]
    s_add_u32 s71, s14, 98304
    buffer_load_dwordx4 a[88:91], v119, s[44:47], s71 offen sc1
    v_mfma_f32_16x16x32_bf16 v[20:23], v[40:43], v[108:111], v[20:23]
    s_add_u32 s71, s14, 147456
    buffer_load_dwordx4 a[92:95], v119, s[44:47], s71 offen sc1
    v_mfma_f32_16x16x32_bf16 v[24:27], v[40:43], v[80:83], v[24:27]
    v_mfma_f32_16x16x32_bf16 v[28:31], v[40:43], v[84:87], v[28:31]
    ds_read_b128 v[40:43], v112 offset:1152
    v_mfma_f32_16x16x32_bf16 v[12:15], v[44:47], v[96:99], v[12:15]
    ds_read_b64 v[84:85], v113 offset:1152
    v_mfma_f32_16x16x32_bf16 v[16:19], v[44:47], v[100:103], v[16:19]
    ds_read_b64 v[86:87], v113 offset:1160
    v_mfma_f32_16x16x32_bf16 v[20:23], v[44:47], v[104:107], v[20:23]
    v_mfma_f32_16x16x32_bf16 v[24:27], v[44:47], v[108:111], v[24:27]
    v_mfma_f32_16x16x32_bf16 v[28:31], v[44:47], v[80:83], v[28:31]
    ds_read_b128 v[44:47], v112 offset:1664
    s_waitcnt lgkmcnt(15)
    v_mfma_f32_16x16x32_bf16 v[16:19], v[48:51], v[96:99], v[16:19]
    ds_read_b64 v[80:81], v113 offset:1664
    v_mfma_f32_16x16x32_bf16 v[20:23], v[48:51], v[100:103], v[20:23]
    ds_read_b64 v[82:83], v113 offset:1672
    v_mfma_f32_16x16x32_bf16 v[24:27], v[48:51], v[104:107], v[24:27]
    v_mfma_f32_16x16x32_bf16 v[28:31], v[48:51], v[108:111], v[28:31]
    ds_read_b128 v[48:51], v112 offset:2176
    s_waitcnt lgkmcnt(15)
    v_mfma_f32_16x16x32_bf16 v[20:23], v[52:55], v[96:99], v[20:23]
    v_mfma_f32_16x16x32_bf16 v[24:27], v[52:55], v[100:103], v[24:27]
    v_mfma_f32_16x16x32_bf16 v[28:31], v[52:55], v[104:107], v[28:31]
    ds_read_b128 v[52:55], v112 offset:2688
    s_waitcnt lgkmcnt(15)
    v_mfma_f32_16x16x32_bf16 v[24:27], v[56:59], v[96:99], v[24:27]
    v_mfma_f32_16x16x32_bf16 v[28:31], v[56:59], v[100:103], v[28:31]
    ds_read_b128 v[56:59], v112 offset:3200
    s_waitcnt lgkmcnt(15)
    v_mfma_f32_16x16x32_bf16 v[28:31], v[60:63], v[96:99], v[28:31]
    ds_read_b128 v[60:63], v112 offset:3712
    s_waitcnt lgkmcnt(4)
    v_mfma_f32_16x16x32_bf16 v[0:3], v[32:35], v[64:67], v[0:3]
    ds_read_b64 v[108:109], v113 offset:2240
    v_mfma_f32_16x16x32_bf16 v[4:7], v[32:35], v[68:71], v[4:7]
    ds_read_b64 v[110:111], v113 offset:2248
    v_mfma_f32_16x16x32_bf16 v[8:11], v[32:35], v[72:75], v[8:11]
    s_add_u32 s71, s14, 196608
    buffer_load_dwordx4 a[96:99], v119, s[44:47], s71 offen sc1
    v_mfma_f32_16x16x32_bf16 v[12:15], v[32:35], v[76:79], v[12:15]
    ds_read_b64 v[104:105], v113 offset:2752
    v_mfma_f32_16x16x32_bf16 v[16:19], v[32:35], v[80:83], v[16:19]
    ds_read_b64 v[106:107], v113 offset:2760
    v_mfma_f32_16x16x32_bf16 v[20:23], v[32:35], v[84:87], v[20:23]
    buffer_load_dwordx4 a[100:103], v119, s[44:47], s15 offen sc1
    v_mfma_f32_16x16x32_bf16 v[24:27], v[32:35], v[88:91], v[24:27]
    ds_read_b64 v[100:101], v113 offset:3264
    v_mfma_f32_16x16x32_bf16 v[28:31], v[32:35], v[92:95], v[28:31]
    ds_read_b128 v[32:35], v112 offset:192
    v_mfma_f32_16x16x32_bf16 v[4:7], v[36:39], v[64:67], v[4:7]
    ds_read_b64 v[92:93], v113 offset:192
    v_mfma_f32_16x16x32_bf16 v[8:11], v[36:39], v[68:71], v[8:11]
    ds_read_b64 v[94:95], v113 offset:200
    v_mfma_f32_16x16x32_bf16 v[12:15], v[36:39], v[72:75], v[12:15]
    ds_read_b64 v[102:103], v113 offset:3272
    v_mfma_f32_16x16x32_bf16 v[16:19], v[36:39], v[76:79], v[16:19]
    s_add_u32 s71, s15, 49152
    buffer_load_dwordx4 a[104:107], v119, s[44:47], s71 offen sc1
    v_mfma_f32_16x16x32_bf16 v[20:23], v[36:39], v[80:83], v[20:23]
    ds_read_b64 v[96:97], v113 offset:3776
    v_mfma_f32_16x16x32_bf16 v[24:27], v[36:39], v[84:87], v[24:27]
    ds_read_b64 v[98:99], v113 offset:3784
    v_mfma_f32_16x16x32_bf16 v[28:31], v[36:39], v[88:91], v[28:31]
    ds_read_b128 v[36:39], v112 offset:704
    v_mfma_f32_16x16x32_bf16 v[8:11], v[40:43], v[64:67], v[8:11]
    ds_read_b64 v[88:89], v113 offset:704
    v_mfma_f32_16x16x32_bf16 v[12:15], v[40:43], v[68:71], v[12:15]
    ds_read_b64 v[90:91], v113 offset:712
    v_mfma_f32_16x16x32_bf16 v[16:19], v[40:43], v[72:75], v[16:19]
    s_add_u32 s71, s15, 98304
    buffer_load_dwordx4 a[108:111], v119, s[44:47], s71 offen sc1
    v_mfma_f32_16x16x32_bf16 v[20:23], v[40:43], v[76:79], v[20:23]
    s_add_u32 s71, s15, 147456
    buffer_load_dwordx4 a[112:115], v119, s[44:47], s71 offen sc1
    v_mfma_f32_16x16x32_bf16 v[24:27], v[40:43], v[80:83], v[24:27]
    v_mfma_f32_16x16x32_bf16 v[28:31], v[40:43], v[84:87], v[28:31]
    ds_read_b128 v[40:43], v112 offset:1216
    v_mfma_f32_16x16x32_bf16 v[12:15], v[44:47], v[64:67], v[12:15]
    ds_read_b64 v[84:85], v113 offset:1216
    v_mfma_f32_16x16x32_bf16 v[16:19], v[44:47], v[68:71], v[16:19]
    ds_read_b64 v[86:87], v113 offset:1224
    v_mfma_f32_16x16x32_bf16 v[20:23], v[44:47], v[72:75], v[20:23]
    v_mfma_f32_16x16x32_bf16 v[24:27], v[44:47], v[76:79], v[24:27]
    v_mfma_f32_16x16x32_bf16 v[28:31], v[44:47], v[80:83], v[28:31]
    ds_read_b128 v[44:47], v112 offset:1728
    s_waitcnt lgkmcnt(15)
    v_mfma_f32_16x16x32_bf16 v[16:19], v[48:51], v[64:67], v[16:19]
    ds_read_b64 v[80:81], v113 offset:1728
    v_mfma_f32_16x16x32_bf16 v[20:23], v[48:51], v[68:71], v[20:23]
    ds_read_b64 v[82:83], v113 offset:1736
    v_mfma_f32_16x16x32_bf16 v[24:27], v[48:51], v[72:75], v[24:27]
    v_mfma_f32_16x16x32_bf16 v[28:31], v[48:51], v[76:79], v[28:31]
    ds_read_b128 v[48:51], v112 offset:2240
    s_waitcnt lgkmcnt(15)
    v_mfma_f32_16x16x32_bf16 v[20:23], v[52:55], v[64:67], v[20:23]
    v_mfma_f32_16x16x32_bf16 v[24:27], v[52:55], v[68:71], v[24:27]
    v_mfma_f32_16x16x32_bf16 v[28:31], v[52:55], v[72:75], v[28:31]
    ds_read_b128 v[52:55], v112 offset:2752
    s_waitcnt lgkmcnt(15)
    v_mfma_f32_16x16x32_bf16 v[24:27], v[56:59], v[64:67], v[24:27]
    v_mfma_f32_16x16x32_bf16 v[28:31], v[56:59], v[68:71], v[28:31]
    ds_read_b128 v[56:59], v112 offset:3264
    s_waitcnt lgkmcnt(15)
    v_mfma_f32_16x16x32_bf16 v[28:31], v[60:63], v[64:67], v[28:31]
    ds_read_b128 v[60:63], v112 offset:3776
    s_waitcnt lgkmcnt(4)
    v_mfma_f32_16x16x32_bf16 v[0:3], v[32:35], v[96:99], v[0:3]
    ds_read_b64 v[76:77], v113 offset:2304
    v_mfma_f32_16x16x32_bf16 v[4:7], v[32:35], v[100:103], v[4:7]
    ds_read_b64 v[78:79], v113 offset:2312
    v_mfma_f32_16x16x32_bf16 v[8:11], v[32:35], v[104:107], v[8:11]
    s_add_u32 s71, s15, 196608
    buffer_load_dwordx4 a[116:119], v119, s[44:47], s71 offen sc1
    v_mfma_f32_16x16x32_bf16 v[12:15], v[32:35], v[108:111], v[12:15]
    ds_read_b64 v[72:73], v113 offset:2816
    v_mfma_f32_16x16x32_bf16 v[16:19], v[32:35], v[80:83], v[16:19]
    ds_read_b64 v[74:75], v113 offset:2824
    v_mfma_f32_16x16x32_bf16 v[20:23], v[32:35], v[84:87], v[20:23]
    v_mfma_f32_16x16x32_bf16 v[24:27], v[32:35], v[88:91], v[24:27]
    ds_read_b64 v[68:69], v113 offset:3328
    v_mfma_f32_16x16x32_bf16 v[28:31], v[32:35], v[92:95], v[28:31]
    ds_read_b128 v[32:35], v112 offset:256
    v_mfma_f32_16x16x32_bf16 v[4:7], v[36:39], v[96:99], v[4:7]
    ds_read_b64 v[92:93], v113 offset:256
    v_mfma_f32_16x16x32_bf16 v[8:11], v[36:39], v[100:103], v[8:11]
    ds_read_b64 v[94:95], v113 offset:264
    v_mfma_f32_16x16x32_bf16 v[12:15], v[36:39], v[104:107], v[12:15]
    ds_read_b64 v[70:71], v113 offset:3336
    v_mfma_f32_16x16x32_bf16 v[16:19], v[36:39], v[108:111], v[16:19]
    v_mfma_f32_16x16x32_bf16 v[20:23], v[36:39], v[80:83], v[20:23]
    ds_read_b64 v[64:65], v113 offset:3840
    v_mfma_f32_16x16x32_bf16 v[24:27], v[36:39], v[84:87], v[24:27]
    ds_read_b64 v[66:67], v113 offset:3848
    v_mfma_f32_16x16x32_bf16 v[28:31], v[36:39], v[88:91], v[28:31]
    ds_read_b128 v[36:39], v112 offset:768
    v_mfma_f32_16x16x32_bf16 v[8:11], v[40:43], v[96:99], v[8:11]
    ds_read_b64 v[88:89], v113 offset:768
    v_mfma_f32_16x16x32_bf16 v[12:15], v[40:43], v[100:103], v[12:15]
    ds_read_b64 v[90:91], v113 offset:776
    v_mfma_f32_16x16x32_bf16 v[16:19], v[40:43], v[104:107], v[16:19]
    v_mfma_f32_16x16x32_bf16 v[20:23], v[40:43], v[108:111], v[20:23]
    v_mfma_f32_16x16x32_bf16 v[24:27], v[40:43], v[80:83], v[24:27]
    v_mfma_f32_16x16x32_bf16 v[28:31], v[40:43], v[84:87], v[28:31]
    ds_read_b128 v[40:43], v112 offset:1280
    v_mfma_f32_16x16x32_bf16 v[12:15], v[44:47], v[96:99], v[12:15]
    ds_read_b64 v[84:85], v113 offset:1280
    v_mfma_f32_16x16x32_bf16 v[16:19], v[44:47], v[100:103], v[16:19]
    ds_read_b64 v[86:87], v113 offset:1288
    v_mfma_f32_16x16x32_bf16 v[20:23], v[44:47], v[104:107], v[20:23]
    v_mfma_f32_16x16x32_bf16 v[24:27], v[44:47], v[108:111], v[24:27]
    v_mfma_f32_16x16x32_bf16 v[28:31], v[44:47], v[80:83], v[28:31]
    ds_read_b128 v[44:47], v112 offset:1792
    s_waitcnt lgkmcnt(15)
    v_mfma_f32_16x16x32_bf16 v[16:19], v[48:51], v[96:99], v[16:19]
    ds_read_b64 v[80:81], v113 offset:1792
    v_mfma_f32_16x16x32_bf16 v[20:23], v[48:51], v[100:103], v[20:23]
    ds_read_b64 v[82:83], v113 offset:1800
    v_mfma_f32_16x16x32_bf16 v[24:27], v[48:51], v[104:107], v[24:27]
    v_mfma_f32_16x16x32_bf16 v[28:31], v[48:51], v[108:111], v[28:31]
    ds_read_b128 v[48:51], v112 offset:2304
    s_waitcnt lgkmcnt(15)
    v_mfma_f32_16x16x32_bf16 v[20:23], v[52:55], v[96:99], v[20:23]
    v_mfma_f32_16x16x32_bf16 v[24:27], v[52:55], v[100:103], v[24:27]
    v_mfma_f32_16x16x32_bf16 v[28:31], v[52:55], v[104:107], v[28:31]
    ds_read_b128 v[52:55], v112 offset:2816
    s_waitcnt lgkmcnt(15)
    v_mfma_f32_16x16x32_bf16 v[24:27], v[56:59], v[96:99], v[24:27]
    v_mfma_f32_16x16x32_bf16 v[28:31], v[56:59], v[100:103], v[28:31]
    ds_read_b128 v[56:59], v112 offset:3328
    s_waitcnt lgkmcnt(15)
    v_mfma_f32_16x16x32_bf16 v[28:31], v[60:63], v[96:99], v[28:31]
    ds_read_b128 v[60:63], v112 offset:3840
    s_waitcnt lgkmcnt(4)
    v_mfma_f32_16x16x32_bf16 v[0:3], v[32:35], v[64:67], v[0:3]
    ds_read_b64 v[108:109], v113 offset:2368
    v_mfma_f32_16x16x32_bf16 v[4:7], v[32:35], v[68:71], v[4:7]
    ds_read_b64 v[110:111], v113 offset:2376
    v_mfma_f32_16x16x32_bf16 v[8:11], v[32:35], v[72:75], v[8:11]
    v_mfma_f32_16x16x32_bf16 v[12:15], v[32:35], v[76:79], v[12:15]
    ds_read_b64 v[104:105], v113 offset:2880
    v_mfma_f32_16x16x32_bf16 v[16:19], v[32:35], v[80:83], v[16:19]
    ds_read_b64 v[106:107], v113 offset:2888
    v_mfma_f32_16x16x32_bf16 v[20:23], v[32:35], v[84:87], v[20:23]
    v_mfma_f32_16x16x32_bf16 v[24:27], v[32:35], v[88:91], v[24:27]
    ds_read_b64 v[100:101], v113 offset:3392
    v_mfma_f32_16x16x32_bf16 v[28:31], v[32:35], v[92:95], v[28:31]
    ds_read_b128 v[32:35], v112 offset:320
    v_mfma_f32_16x16x32_bf16 v[4:7], v[36:39], v[64:67], v[4:7]
    ds_read_b64 v[92:93], v113 offset:320
    v_mfma_f32_16x16x32_bf16 v[8:11], v[36:39], v[68:71], v[8:11]
    ds_read_b64 v[94:95], v113 offset:328
    v_mfma_f32_16x16x32_bf16 v[12:15], v[36:39], v[72:75], v[12:15]
    ds_read_b64 v[102:103], v113 offset:3400
    v_mfma_f32_16x16x32_bf16 v[16:19], v[36:39], v[76:79], v[16:19]
    v_mfma_f32_16x16x32_bf16 v[20:23], v[36:39], v[80:83], v[20:23]
    ds_read_b64 v[96:97], v113 offset:3904
    v_mfma_f32_16x16x32_bf16 v[24:27], v[36:39], v[84:87], v[24:27]
    ds_read_b64 v[98:99], v113 offset:3912
    v_mfma_f32_16x16x32_bf16 v[28:31], v[36:39], v[88:91], v[28:31]
    ds_read_b128 v[36:39], v112 offset:832
    v_mfma_f32_16x16x32_bf16 v[8:11], v[40:43], v[64:67], v[8:11]
    ds_read_b64 v[88:89], v113 offset:832
    v_mfma_f32_16x16x32_bf16 v[12:15], v[40:43], v[68:71], v[12:15]
    ds_read_b64 v[90:91], v113 offset:840
    v_mfma_f32_16x16x32_bf16 v[16:19], v[40:43], v[72:75], v[16:19]
    v_mfma_f32_16x16x32_bf16 v[20:23], v[40:43], v[76:79], v[20:23]
    v_mfma_f32_16x16x32_bf16 v[24:27], v[40:43], v[80:83], v[24:27]
    v_mfma_f32_16x16x32_bf16 v[28:31], v[40:43], v[84:87], v[28:31]
    ds_read_b128 v[40:43], v112 offset:1344
    v_mfma_f32_16x16x32_bf16 v[12:15], v[44:47], v[64:67], v[12:15]
    ds_read_b64 v[84:85], v113 offset:1344
    v_mfma_f32_16x16x32_bf16 v[16:19], v[44:47], v[68:71], v[16:19]
    ds_read_b64 v[86:87], v113 offset:1352
    v_mfma_f32_16x16x32_bf16 v[20:23], v[44:47], v[72:75], v[20:23]
    v_mfma_f32_16x16x32_bf16 v[24:27], v[44:47], v[76:79], v[24:27]
    v_mfma_f32_16x16x32_bf16 v[28:31], v[44:47], v[80:83], v[28:31]
    ds_read_b128 v[44:47], v112 offset:1856
    s_waitcnt lgkmcnt(15)
    v_mfma_f32_16x16x32_bf16 v[16:19], v[48:51], v[64:67], v[16:19]
    ds_read_b64 v[80:81], v113 offset:1856
    v_mfma_f32_16x16x32_bf16 v[20:23], v[48:51], v[68:71], v[20:23]
    ds_read_b64 v[82:83], v113 offset:1864
    v_mfma_f32_16x16x32_bf16 v[24:27], v[48:51], v[72:75], v[24:27]
    v_mfma_f32_16x16x32_bf16 v[28:31], v[48:51], v[76:79], v[28:31]
    ds_read_b128 v[48:51], v112 offset:2368
    s_waitcnt lgkmcnt(15)
    v_mfma_f32_16x16x32_bf16 v[20:23], v[52:55], v[64:67], v[20:23]
    v_mfma_f32_16x16x32_bf16 v[24:27], v[52:55], v[68:71], v[24:27]
    v_mfma_f32_16x16x32_bf16 v[28:31], v[52:55], v[72:75], v[28:31]
    ds_read_b128 v[52:55], v112 offset:2880
    s_waitcnt lgkmcnt(15)
    v_mfma_f32_16x16x32_bf16 v[24:27], v[56:59], v[64:67], v[24:27]
    v_mfma_f32_16x16x32_bf16 v[28:31], v[56:59], v[68:71], v[28:31]
    ds_read_b128 v[56:59], v112 offset:3392
    s_waitcnt lgkmcnt(15)
    v_mfma_f32_16x16x32_bf16 v[28:31], v[60:63], v[64:67], v[28:31]
    ds_read_b128 v[60:63], v112 offset:3904
    s_waitcnt lgkmcnt(4)
    v_mfma_f32_16x16x32_bf16 v[0:3], v[32:35], v[96:99], v[0:3]
    ds_read_b64 v[64:65], v115 offset:3584
    v_mfma_f32_16x16x32_bf16 v[4:7], v[32:35], v[100:103], v[4:7]
    ds_read_b64 v[66:67], v115 offset:3072
    v_mfma_f32_16x16x32_bf16 v[8:11], v[32:35], v[104:107], v[8:11]
    ds_read_b64 v[68:69], v115 offset:2560
    v_mfma_f32_16x16x32_bf16 v[12:15], v[32:35], v[108:111], v[12:15]
    ds_read_b64 v[70:71], v115 offset:2048
    v_mfma_f32_16x16x32_bf16 v[16:19], v[32:35], v[80:83], v[16:19]
    ds_read_b64 v[72:73], v115 offset:1536
    v_mfma_f32_16x16x32_bf16 v[20:23], v[32:35], v[84:87], v[20:23]
    ds_read_b64 v[74:75], v115 offset:1024
    v_mfma_f32_16x16x32_bf16 v[24:27], v[32:35], v[88:91], v[24:27]
    ds_read_b64 v[76:77], v115 offset:512
    v_mfma_f32_16x16x32_bf16 v[28:31], v[32:35], v[92:95], v[28:31]
    ds_read_b64 v[78:79], v115 offset:0
    v_mfma_f32_16x16x32_bf16 v[4:7], v[36:39], v[96:99], v[4:7]
    v_mfma_f32_16x16x32_bf16 v[8:11], v[36:39], v[100:103], v[8:11]
    v_mfma_f32_16x16x32_bf16 v[12:15], v[36:39], v[104:107], v[12:15]
    v_mfma_f32_16x16x32_bf16 v[16:19], v[36:39], v[108:111], v[16:19]
    v_mfma_f32_16x16x32_bf16 v[20:23], v[36:39], v[80:83], v[20:23]
    v_mfma_f32_16x16x32_bf16 v[24:27], v[36:39], v[84:87], v[24:27]
    v_mfma_f32_16x16x32_bf16 v[28:31], v[36:39], v[88:91], v[28:31]
    v_mfma_f32_16x16x32_bf16 v[8:11], v[40:43], v[96:99], v[8:11]
    s_waitcnt lgkmcnt(7)
    v_mfma_f32_16x16x32_bf16 v[12:15], v[40:43], v[100:103], v[12:15]
    v_and_b32 v32, 0xffff0000, v65
    v_lshlrev_b32 v33, 16, v65
    v_mfma_f32_16x16x32_bf16 v[16:19], v[40:43], v[104:107], v[16:19]
    v_and_b32 v34, 0xffff0000, v64
    v_lshlrev_b32 v35, 16, v64
    v_mfma_f32_16x16x32_bf16 v[20:23], v[40:43], v[108:111], v[20:23]
    v_fmac_f32 v0, s75, v32
    v_fmac_f32 v1, s75, v33
    v_mfma_f32_16x16x32_bf16 v[24:27], v[40:43], v[80:83], v[24:27]
    v_fmac_f32 v2, s75, v34
    v_fmac_f32 v3, s75, v35
    v_mfma_f32_16x16x32_bf16 v[28:31], v[40:43], v[84:87], v[28:31]
    v_mfma_f32_16x16x32_bf16 v[12:15], v[44:47], v[96:99], v[12:15]
    s_waitcnt lgkmcnt(6)
    v_mfma_f32_16x16x32_bf16 v[16:19], v[44:47], v[100:103], v[16:19]
    v_and_b32 v36, 0xffff0000, v67
    v_lshlrev_b32 v37, 16, v67
    v_mfma_f32_16x16x32_bf16 v[20:23], v[44:47], v[104:107], v[20:23]
    v_and_b32 v38, 0xffff0000, v66
    v_lshlrev_b32 v39, 16, v66
    v_mfma_f32_16x16x32_bf16 v[24:27], v[44:47], v[108:111], v[24:27]
    v_fmac_f32 v4, s75, v36
    v_fmac_f32 v5, s75, v37
    v_mfma_f32_16x16x32_bf16 v[28:31], v[44:47], v[80:83], v[28:31]
    v_fmac_f32 v6, s75, v38
    v_fmac_f32 v7, s75, v39
    s_waitcnt lgkmcnt(11)
    v_mfma_f32_16x16x32_bf16 v[16:19], v[48:51], v[96:99], v[16:19]
    s_waitcnt lgkmcnt(5)
    v_mfma_f32_16x16x32_bf16 v[20:23], v[48:51], v[100:103], v[20:23]
    v_and_b32 v32, 0xffff0000, v69
    v_lshlrev_b32 v33, 16, v69
    v_mfma_f32_16x16x32_bf16 v[24:27], v[48:51], v[104:107], v[24:27]
    v_and_b32 v34, 0xffff0000, v68
    v_lshlrev_b32 v35, 16, v68
    v_mfma_f32_16x16x32_bf16 v[28:31], v[48:51], v[108:111], v[28:31]
    v_fmac_f32 v8, s75, v32
    v_fmac_f32 v9, s75, v33
    s_waitcnt lgkmcnt(10)
    v_mfma_f32_16x16x32_bf16 v[20:23], v[52:55], v[96:99], v[20:23]
    v_fmac_f32 v10, s75, v34
    v_fmac_f32 v11, s75, v35
    v_mfma_f32_16x16x32_bf16 v[24:27], v[52:55], v[100:103], v[24:27]
    s_waitcnt lgkmcnt(4)
    v_mfma_f32_16x16x32_bf16 v[28:31], v[52:55], v[104:107], v[28:31]
    v_and_b32 v36, 0xffff0000, v71
    v_lshlrev_b32 v37, 16, v71
    s_waitcnt lgkmcnt(9)
    v_mfma_f32_16x16x32_bf16 v[24:27], v[56:59], v[96:99], v[24:27]
    v_and_b32 v38, 0xffff0000, v70
    v_lshlrev_b32 v39, 16, v70
    v_mfma_f32_16x16x32_bf16 v[28:31], v[56:59], v[100:103], v[28:31]
    v_fmac_f32 v12, s75, v36
    v_fmac_f32 v13, s75, v37
    s_waitcnt lgkmcnt(8)
    v_mfma_f32_16x16x32_bf16 v[28:31], v[60:63], v[96:99], v[28:31]
    v_fmac_f32 v14, s75, v38
    v_fmac_f32 v15, s75, v39
    s_waitcnt lgkmcnt(3)
    v_and_b32 v32, 0xffff0000, v73
    v_lshlrev_b32 v33, 16, v73
    v_and_b32 v34, 0xffff0000, v72
    v_lshlrev_b32 v35, 16, v72
    v_fmac_f32 v16, s75, v32
    v_fmac_f32 v17, s75, v33
    v_fmac_f32 v18, s75, v34
    v_fmac_f32 v19, s75, v35
    s_waitcnt lgkmcnt(2)
    v_and_b32 v36, 0xffff0000, v75
    v_lshlrev_b32 v37, 16, v75
    v_and_b32 v38, 0xffff0000, v74
    v_lshlrev_b32 v39, 16, v74
    v_fmac_f32 v20, s75, v36
    v_fmac_f32 v21, s75, v37
    v_fmac_f32 v22, s75, v38
    v_fmac_f32 v23, s75, v39
    s_waitcnt lgkmcnt(1)
    v_and_b32 v32, 0xffff0000, v77
    v_lshlrev_b32 v33, 16, v77
    v_and_b32 v34, 0xffff0000, v76
    v_lshlrev_b32 v35, 16, v76
    v_fmac_f32 v24, s75, v32
    v_fmac_f32 v25, s75, v33
    v_fmac_f32 v26, s75, v34
    v_fmac_f32 v27, s75, v35
    s_waitcnt lgkmcnt(0)
    v_and_b32 v36, 0xffff0000, v79
    v_lshlrev_b32 v37, 16, v79
    v_and_b32 v38, 0xffff0000, v78
    v_lshlrev_b32 v39, 16, v78
    v_fmac_f32 v28, s75, v36
    v_fmac_f32 v29, s75, v37
    v_fmac_f32 v30, s75, v38
    v_fmac_f32 v31, s75, v39
    v_mov_b32 v124, 163344
    s_mov_b32 s73, 0
L_lw49:
    ds_read_b32 v125, v124
    s_add_u32 s73, s73, 1
    s_waitcnt lgkmcnt(0)
    v_cmp_eq_u32 vcc, 0, v125
    s_nop 1
    s_cbranch_vccz L_lw49_ok
    s_sleep 1
    s_cmp_lt_u32 s73, 3200000
    s_cbranch_scc1 L_lw49
L_lw49_ok:
    s_add_u32 s71, s22, s10
    buffer_load_dwordx4 v[40:43], v126, s[44:47], s71 offen sc1
    s_add_u32 s71, s22, s11
    buffer_load_dwordx4 v[44:47], v126, s[44:47], s71 offen sc1
    s_add_u32 s71, s22, s12
    buffer_load_dwordx4 v[48:51], v126, s[44:47], s71 offen sc1
    s_add_u32 s71, s22, s13
    buffer_load_dwordx4 v[52:55], v126, s[44:47], s71 offen sc1
    s_add_u32 s71, s22, s14
    buffer_load_dwordx4 v[56:59], v126, s[44:47], s71 offen sc1
    s_add_u32 s71, s22, s15
    buffer_load_dwordx4 v[60:63], v126, s[44:47], s71 offen sc1
    s_add_u32 s71, s23, s10
    buffer_load_dwordx4 v[64:67], v126, s[44:47], s71 offen sc1
    s_add_u32 s71, s23, s11
    buffer_load_dwordx4 v[68:71], v126, s[44:47], s71 offen sc1
    s_add_u32 s71, s23, s12
    buffer_load_dwordx4 v[72:75], v126, s[44:47], s71 offen sc1
    s_add_u32 s71, s23, s13
    buffer_load_dwordx4 v[76:79], v126, s[44:47], s71 offen sc1
    s_lshl_b32 s72, s3, 2
    s_add_u32 s72, s72, 163552
    v_mov_b32 v124, s72
    s_mov_b32 s73, 0
L_lw50:
    ds_read_b32 v125, v124
    s_add_u32 s73, s73, 1
    s_waitcnt lgkmcnt(0)
    v_cmp_eq_u32 vcc, 0, v125
    s_nop 1
    s_cbranch_vccz L_lw50_ok
    s_sleep 1
    s_cmp_lt_u32 s73, 3200000
    s_cbranch_scc1 L_lw50
L_lw50_ok:
    ds_read_b128 v[80:83], v117 offset:0
    ds_read_b128 v[84:87], v117 offset:1024
    ds_read_b128 v[88:91], v117 offset:2048
    ds_read_b128 v[92:95], v117 offset:3072
    ds_read_b128 v[96:99], v117 offset:4096
    ds_read_b128 v[100:103], v117 offset:5120
    ds_read_b128 v[104:107], v117 offset:6144
    ds_read_b128 v[108:111], v117 offset:7168
    s_waitcnt lgkmcnt(7)
    v_add_f32 v0, v0, v80
    v_add_f32 v1, v1, v81
    v_add_f32 v2, v2, v82
    v_add_f32 v3, v3, v83
    s_waitcnt lgkmcnt(6)
    v_add_f32 v4, v4, v84
    v_add_f32 v5, v5, v85
    v_add_f32 v6, v6, v86
    v_add_f32 v7, v7, v87
    s_waitcnt lgkmcnt(5)
    v_add_f32 v8, v8, v88
    v_add_f32 v9, v9, v89
    v_add_f32 v10, v10, v90
    v_add_f32 v11, v11, v91
    s_waitcnt lgkmcnt(4)
    v_add_f32 v12, v12, v92
    v_add_f32 v13, v13, v93
    v_add_f32 v14, v14, v94
    v_add_f32 v15, v15, v95
    s_waitcnt lgkmcnt(3)
    v_add_f32 v16, v16, v96
    v_add_f32 v17, v17, v97
    v_add_f32 v18, v18, v98
    v_add_f32 v19, v19, v99
    s_waitcnt lgkmcnt(2)
    v_add_f32 v20, v20, v100
    v_add_f32 v21, v21, v101
    v_add_f32 v22, v22, v102
    v_add_f32 v23, v23, v103
    s_waitcnt lgkmcnt(1)
    v_add_f32 v24, v24, v104
    v_add_f32 v25, v25, v105
    v_add_f32 v26, v26, v106
    v_add_f32 v27, v27, v107
    s_waitcnt lgkmcnt(0)
    v_add_f32 v28, v28, v108
    v_add_f32 v29, v29, v109
    v_add_f32 v30, v30, v110
    v_add_f32 v31, v31, v111
    s_lshl_b32 s72, s3, 2
    s_add_u32 s72, s72, 163568
    v_mov_b32 v124, s72
    ds_write_b32 v124, v124
    s_add_u32 s71, s23, s14
    buffer_load_dwordx4 v[80:83], v126, s[44:47], s71 offen sc1
    s_add_u32 s71, s23, s15
    buffer_load_dwordx4 v[84:87], v126, s[44:47], s71 offen sc1
    v_cvt_pk_bf16_f32 v96, v0, v1
    v_cvt_pk_bf16_f32 v97, v2, v3
    buffer_store_dwordx2 v[96:97], v114, s[44:47], s76 offen offset:0 sc1
    v_cvt_pk_bf16_f32 v98, v4, v5
    v_cvt_pk_bf16_f32 v99, v6, v7
    buffer_store_dwordx2 v[98:99], v114, s[44:47], s76 offen offset:512 sc1
    v_cvt_pk_bf16_f32 v100, v8, v9
    v_cvt_pk_bf16_f32 v101, v10, v11
    buffer_store_dwordx2 v[100:101], v114, s[44:47], s76 offen offset:1024 sc1
    v_cvt_pk_bf16_f32 v102, v12, v13
    v_cvt_pk_bf16_f32 v103, v14, v15
    buffer_store_dwordx2 v[102:103], v114, s[44:47], s76 offen offset:1536 sc1
    v_cvt_pk_bf16_f32 v104, v16, v17
    v_cvt_pk_bf16_f32 v105, v18, v19
    buffer_store_dwordx2 v[104:105], v114, s[44:47], s76 offen offset:2048 sc1
    v_cvt_pk_bf16_f32 v106, v20, v21
    v_cvt_pk_bf16_f32 v107, v22, v23
    buffer_store_dwordx2 v[106:107], v114, s[44:47], s76 offen offset:2560 sc1
    v_cvt_pk_bf16_f32 v108, v24, v25
    v_cvt_pk_bf16_f32 v109, v26, v27
    buffer_store_dwordx2 v[108:109], v114, s[44:47], s76 offen offset:3072 sc1
    v_cvt_pk_bf16_f32 v110, v28, v29
    v_cvt_pk_bf16_f32 v111, v30, v31
    buffer_store_dwordx2 v[110:111], v114, s[44:47], s76 offen offset:3584 sc1
    s_setprio 0
L_conv_done:
    s_lshl_b32 s69, s3, 2
    s_waitcnt vmcnt(11)
    v_mfma_f32_16x16x32_bf16 v[0:3], a[0:3], v[40:43], 0
    v_mfma_f32_16x16x32_bf16 v[4:7], a[4:7], v[40:43], 0
    s_add_u32 s71, s24, s10
    buffer_load_dwordx4 v[88:91], v126, s[44:47], s71 offen sc1
    v_mfma_f32_16x16x32_bf16 v[8:11], a[8:11], v[40:43], 0
    v_mfma_f32_16x16x32_bf16 v[12:15], a[12:15], v[40:43], 0
    v_mfma_f32_16x16x32_bf16 v[16:19], a[16:19], v[40:43], 0
    s_waitcnt vmcnt(11)
    v_mfma_f32_16x16x32_bf16 v[0:3], a[20:23], v[44:47], v[0:3]
    v_mfma_f32_16x16x32_bf16 v[4:7], a[24:27], v[44:47], v[4:7]
    s_add_u32 s71, s24, s11
    buffer_load_dwordx4 v[92:95], v126, s[44:47], s71 offen sc1
    v_mfma_f32_16x16x32_bf16 v[8:11], a[28:31], v[44:47], v[8:11]
    v_mfma_f32_16x16x32_bf16 v[12:15], a[32:35], v[44:47], v[12:15]
    v_mfma_f32_16x16x32_bf16 v[16:19], a[36:39], v[44:47], v[16:19]
    s_waitcnt vmcnt(11)
    v_mfma_f32_16x16x32_bf16 v[0:3], a[40:43], v[48:51], v[0:3]
    v_mfma_f32_16x16x32_bf16 v[4:7], a[44:47], v[48:51], v[4:7]
    s_add_u32 s71, s24, s12
    buffer_load_dwordx4 v[40:43], v126, s[44:47], s71 offen sc1
    v_mfma_f32_16x16x32_bf16 v[8:11], a[48:51], v[48:51], v[8:11]
    v_mfma_f32_16x16x32_bf16 v[12:15], a[52:55], v[48:51], v[12:15]
    v_mfma_f32_16x16x32_bf16 v[16:19], a[56:59], v[48:51], v[16:19]
    s_cmp_lt_i32 s61, 0
    s_cbranch_scc1 L_nofs
    s_lshr_b32 s73, s61, 2
    s_lshl_b32 s73, s73, 7
    s_and_b32 s70, s61, 3
    s_lshl_b32 s70, s70, 2
    s_add_u32 s70, s70, s73
    s_add_u32 s70, s70, 16326656
    s_waitcnt vmcnt(3)
    v_mov_b32 v124, s60
    s_mov_b64 exec, 1
    buffer_store_dword v124, v126, s[44:47], s70 offen sc1
    s_mov_b64 exec, -1
L_nofs:
    s_waitcnt vmcnt(11)
    v_mfma_f32_16x16x32_bf16 v[0:3], a[60:63], v[52:55], v[0:3]
    v_mfma_f32_16x16x32_bf16 v[4:7], a[64:67], v[52:55], v[4:7]
    s_add_u32 s71, s24, s13
    buffer_load_dwordx4 v[44:47], v126, s[44:47], s71 offen sc1
    v_mfma_f32_16x16x32_bf16 v[8:11], a[68:71], v[52:55], v[8:11]
    v_mfma_f32_16x16x32_bf16 v[12:15], a[72:75], v[52:55], v[12:15]
    v_mfma_f32_16x16x32_bf16 v[16:19], a[76:79], v[52:55], v[16:19]
    s_waitcnt vmcnt(11)
    v_mfma_f32_16x16x32_bf16 v[0:3], a[80:83], v[56:59], v[0:3]
    v_mfma_f32_16x16x32_bf16 v[4:7], a[84:87], v[56:59], v[4:7]
    s_add_u32 s71, s24, s14
    buffer_load_dwordx4 v[48:51], v126, s[44:47], s71 offen sc1
    v_mfma_f32_16x16x32_bf16 v[8:11], a[88:91], v[56:59], v[8:11]
    v_mfma_f32_16x16x32_bf16 v[12:15], a[92:95], v[56:59], v[12:15]
    v_mfma_f32_16x16x32_bf16 v[16:19], a[96:99], v[56:59], v[16:19]
    s_waitcnt vmcnt(11)
    v_mfma_f32_16x16x32_bf16 v[0:3], a[100:103], v[60:63], v[0:3]
    v_mfma_f32_16x16x32_bf16 v[4:7], a[104:107], v[60:63], v[4:7]
    s_add_u32 s71, s24, s15
    buffer_load_dwordx4 v[52:55], v126, s[44:47], s71 offen sc1
    v_mfma_f32_16x16x32_bf16 v[8:11], a[108:111], v[60:63], v[8:11]
    v_mfma_f32_16x16x32_bf16 v[12:15], a[112:115], v[60:63], v[12:15]
    v_mfma_f32_16x16x32_bf16 v[16:19], a[116:119], v[60:63], v[16:19]
    s_waitcnt vmcnt(11)
    v_mfma_f32_16x16x32_bf16 v[20:23], a[0:3], v[64:67], 0
    v_mfma_f32_16x16x32_bf16 v[24:27], a[4:7], v[64:67], 0
    s_add_u32 s71, s25, s10
    buffer_load_dwordx4 v[56:59], v126, s[44:47], s71 offen sc1
    v_mfma_f32_16x16x32_bf16 v[28:31], a[8:11], v[64:67], 0
    v_mfma_f32_16x16x32_bf16 v[32:35], a[12:15], v[64:67], 0
    v_mfma_f32_16x16x32_bf16 v[36:39], a[16:19], v[64:67], 0
    s_waitcnt vmcnt(11)
    v_mfma_f32_16x16x32_bf16 v[20:23], a[20:23], v[68:71], v[20:23]
    v_mfma_f32_16x16x32_bf16 v[24:27], a[24:27], v[68:71], v[24:27]
    s_add_u32 s71, s25, s11
    buffer_load_dwordx4 v[60:63], v126, s[44:47], s71 offen sc1
    v_mfma_f32_16x16x32_bf16 v[28:31], a[28:31], v[68:71], v[28:31]
    v_mfma_f32_16x16x32_bf16 v[32:35], a[32:35], v[68:71], v[32:35]
    ds_write_b128 v116, v[0:3] offset:0
    v_mfma_f32_16x16x32_bf16 v[36:39], a[36:39], v[68:71], v[36:39]
    s_waitcnt vmcnt(11)
    v_mfma_f32_16x16x32_bf16 v[20:23], a[40:43], v[72:75], v[20:23]
    v_mfma_f32_16x16x32_bf16 v[24:27], a[44:47], v[72:75], v[24:27]
    s_add_u32 s71, s25, s12
    buffer_load_dwordx4 v[64:67], v126, s[44:47], s71 offen sc1
    v_mfma_f32_16x16x32_bf16 v[28:31], a[48:51], v[72:75], v[28:31]
    v_mfma_f32_16x16x32_bf16 v[32:35], a[52:55], v[72:75], v[32:35]
    ds_write_b128 v116, v[4:7] offset:1024
    v_mfma_f32_16x16x32_bf16 v[36:39], a[56:59], v[72:75], v[36:39]
    s_waitcnt vmcnt(11)
    v_mfma_f32_16x16x32_bf16 v[20:23], a[60:63], v[76:79], v[20:23]
    v_mfma_f32_16x16x32_bf16 v[24:27], a[64:67], v[76:79], v[24:27]
    s_add_u32 s71, s25, s13
    buffer_load_dwordx4 v[68:71], v126, s[44:47], s71 offen sc1
    v_mfma_f32_16x16x32_bf16 v[28:31], a[68:71], v[76:79], v[28:31]
    v_mfma_f32_16x16x32_bf16 v[32:35], a[72:75], v[76:79], v[32:35]
    ds_write_b128 v116, v[8:11] offset:2048
    v_mfma_f32_16x16x32_bf16 v[36:39], a[76:79], v[76:79], v[36:39]
    s_waitcnt vmcnt(11)
    v_mfma_f32_16x16x32_bf16 v[20:23], a[80:83], v[80:83], v[20:23]
    v_mfma_f32_16x16x32_bf16 v[24:27], a[84:87], v[80:83], v[24:27]
    s_add_u32 s71, s25, s14
    buffer_load_dwordx4 v[72:75], v126, s[44:47], s71 offen sc1
    v_mfma_f32_16x16x32_bf16 v[28:31], a[88:91], v[80:83], v[28:31]
    v_mfma_f32_16x16x32_bf16 v[32:35], a[92:95], v[80:83], v[32:35]
    ds_write_b128 v116, v[12:15] offset:3072
    v_mfma_f32_16x16x32_bf16 v[36:39], a[96:99], v[80:83], v[36:39]
    s_waitcnt vmcnt(11)
    v_mfma_f32_16x16x32_bf16 v[20:23], a[100:103], v[84:87], v[20:23]
    v_mfma_f32_16x16x32_bf16 v[24:27], a[104:107], v[84:87], v[24:27]
    s_add_u32 s71, s25, s15
    buffer_load_dwordx4 v[76:79], v126, s[44:47], s71 offen sc1
    v_mfma_f32_16x16x32_bf16 v[28:31], a[108:111], v[84:87], v[28:31]
    v_mfma_f32_16x16x32_bf16 v[32:35], a[112:115], v[84:87], v[32:35]
    ds_write_b128 v116, v[16:19] offset:4096
    s_lshl_b32 s72, s69, 2
    s_add_u32 s72, s72, 163456
    v_mov_b32 v124, s72
    ds_write_b32 v124, v124
    v_mfma_f32_16x16x32_bf16 v[36:39], a[116:119], v[84:87], v[36:39]
    s_waitcnt vmcnt(11)
    v_mfma_f32_16x16x32_bf16 v[0:3], a[0:3], v[88:91], 0
    v_mfma_f32_16x16x32_bf16 v[4:7], a[4:7], v[88:91], 0
    v_mfma_f32_16x16x32_bf16 v[8:11], a[8:11], v[88:91], 0
    v_mfma_f32_16x16x32_bf16 v[12:15], a[12:15], v[88:91], 0
    v_mfma_f32_16x16x32_bf16 v[16:19], a[16:19], v[88:91], 0
    s_waitcnt vmcnt(10)
    v_mfma_f32_16x16x32_bf16 v[0:3], a[20:23], v[92:95], v[0:3]
    v_mfma_f32_16x16x32_bf16 v[4:7], a[24:27], v[92:95], v[4:7]
    v_mfma_f32_16x16x32_bf16 v[8:11], a[28:31], v[92:95], v[8:11]
    v_mfma_f32_16x16x32_bf16 v[12:15], a[32:35], v[92:95], v[12:15]
    ds_write_b128 v116, v[20:23] offset:5120
    v_mfma_f32_16x16x32_bf16 v[16:19], a[36:39], v[92:95], v[16:19]
    s_waitcnt vmcnt(9)
    v_mfma_f32_16x16x32_bf16 v[0:3], a[40:43], v[40:43], v[0:3]
    v_mfma_f32_16x16x32_bf16 v[4:7], a[44:47], v[40:43], v[4:7]
    v_mfma_f32_16x16x32_bf16 v[8:11], a[48:51], v[40:43], v[8:11]
    v_mfma_f32_16x16x32_bf16 v[12:15], a[52:55], v[40:43], v[12:15]
    ds_write_b128 v116, v[24:27] offset:6144
    v_mfma_f32_16x16x32_bf16 v[16:19], a[56:59], v[40:43], v[16:19]
    s_waitcnt vmcnt(8)
    v_mfma_f32_16x16x32_bf16 v[0:3], a[60:63], v[44:47], v[0:3]
    v_mfma_f32_16x16x32_bf16 v[4:7], a[64:67], v[44:47], v[4:7]
    v_mfma_f32_16x16x32_bf16 v[8:11], a[68:71], v[44:47], v[8:11]
    v_mfma_f32_16x16x32_bf16 v[12:15], a[72:75], v[44:47], v[12:15]
    ds_write_b128 v116, v[28:31] offset:7168
    v_mfma_f32_16x16x32_bf16 v[16:19], a[76:79], v[44:47], v[16:19]
    s_waitcnt vmcnt(7)
    v_mfma_f32_16x16x32_bf16 v[0:3], a[80:83], v[48:51], v[0:3]
    v_mfma_f32_16x16x32_bf16 v[4:7], a[84:87], v[48:51], v[4:7]
    v_mfma_f32_16x16x32_bf16 v[8:11], a[88:91], v[48:51], v[8:11]
    v_mfma_f32_16x16x32_bf16 v[12:15], a[92:95], v[48:51], v[12:15]
    ds_write_b128 v116, v[32:35] offset:8192
    v_mfma_f32_16x16x32_bf16 v[16:19], a[96:99], v[48:51], v[16:19]
    s_waitcnt vmcnt(6)
    v_mfma_f32_16x16x32_bf16 v[0:3], a[100:103], v[52:55], v[0:3]
    v_mfma_f32_16x16x32_bf16 v[4:7], a[104:107], v[52:55], v[4:7]
    v_mfma_f32_16x16x32_bf16 v[8:11], a[108:111], v[52:55], v[8:11]
    v_mfma_f32_16x16x32_bf16 v[12:15], a[112:115], v[52:55], v[12:15]
    ds_write_b128 v116, v[36:39] offset:9216
    s_lshl_b32 s72, s69, 2
    s_add_u32 s72, s72, 163460
    v_mov_b32 v124, s72
    ds_write_b32 v124, v124
    v_mfma_f32_16x16x32_bf16 v[16:19], a[116:119], v[52:55], v[16:19]
    s_waitcnt vmcnt(5)
    v_mfma_f32_16x16x32_bf16 v[20:23], a[0:3], v[56:59], 0
    v_mfma_f32_16x16x32_bf16 v[24:27], a[4:7], v[56:59], 0
    v_mfma_f32_16x16x32_bf16 v[28:31], a[8:11], v[56:59], 0
    v_mfma_f32_16x16x32_bf16 v[32:35], a[12:15], v[56:59], 0
    v_mfma_f32_16x16x32_bf16 v[36:39], a[16:19], v[56:59], 0
    s_waitcnt vmcnt(4)
    v_mfma_f32_16x16x32_bf16 v[20:23], a[20:23], v[60:63], v[20:23]
    v_mfma_f32_16x16x32_bf16 v[24:27], a[24:27], v[60:63], v[24:27]
    v_mfma_f32_16x16x32_bf16 v[28:31], a[28:31], v[60:63], v[28:31]
    v_mfma_f32_16x16x32_bf16 v[32:35], a[32:35], v[60:63], v[32:35]
    ds_write_b128 v116, v[0:3] offset:10240
    v_mfma_f32_16x16x32_bf16 v[36:39], a[36:39], v[60:63], v[36:39]
    s_waitcnt vmcnt(3)
    v_mfma_f32_16x16x32_bf16 v[20:23], a[40:43], v[64:67], v[20:23]
    v_mfma_f32_16x16x32_bf16 v[24:27], a[44:47], v[64:67], v[24:27]
    v_mfma_f32_16x16x32_bf16 v[28:31], a[48:51], v[64:67], v[28:31]
    v_mfma_f32_16x16x32_bf16 v[32:35], a[52:55], v[64:67], v[32:35]
    ds_write_b128 v116, v[4:7] offset:11264
    v_mfma_f32_16x16x32_bf16 v[36:39], a[56:59], v[64:67], v[36:39]
    s_waitcnt vmcnt(2)
    v_mfma_f32_16x16x32_bf16 v[20:23], a[60:63], v[68:71], v[20:23]
    v_mfma_f32_16x16x32_bf16 v[24:27], a[64:67], v[68:71], v[24:27]
    v_mfma_f32_16x16x32_bf16 v[28:31], a[68:71], v[68:71], v[28:31]
    v_mfma_f32_16x16x32_bf16 v[32:35], a[72:75], v[68:71], v[32:35]
    ds_write_b128 v116, v[8:11] offset:12288
    v_mfma_f32_16x16x32_bf16 v[36:39], a[76:79], v[68:71], v[36:39]
    s_waitcnt vmcnt(1)
    v_mfma_f32_16x16x32_bf16 v[20:23], a[80:83], v[72:75], v[20:23]
    v_mfma_f32_16x16x32_bf16 v[24:27], a[84:87], v[72:75], v[24:27]
    v_mfma_f32_16x16x32_bf16 v[28:31], a[88:91], v[72:75], v[28:31]
    v_mfma_f32_16x16x32_bf16 v[32:35], a[92:95], v[72:75], v[32:35]
    ds_write_b128 v116, v[12:15] offset:13312
    v_mfma_f32_16x16x32_bf16 v[36:39], a[96:99], v[72:75], v[36:39]
    s_waitcnt vmcnt(0)
    v_mfma_f32_16x16x32_bf16 v[20:23], a[100:103], v[76:79], v[20:23]
    v_mfma_f32_16x16x32_bf16 v[24:27], a[104:107], v[76:79], v[24:27]
    v_mfma_f32_16x16x32_bf16 v[28:31], a[108:111], v[76:79], v[28:31]
    v_mfma_f32_16x16x32_bf16 v[32:35], a[112:115], v[76:79], v[32:35]
    ds_write_b128 v116, v[16:19] offset:14336
    s_lshl_b32 s72, s69, 2
    s_add_u32 s72, s72, 163464
    v_mov_b32 v124, s72
    ds_write_b32 v124, v124
    v_mfma_f32_16x16x32_bf16 v[36:39], a[116:119], v[76:79], v[36:39]
    ds_write_b128 v116, v[20:23] offset:15360
    ds_write_b128 v116, v[24:27] offset:16384
    ds_write_b128 v116, v[28:31] offset:17408
    ds_write_b128 v116, v[32:35] offset:18432
    s_nop 3
    ds_write_b128 v116, v[36:39] offset:19456
    s_lshl_b32 s72, s69, 2
    s_add_u32 s72, s72, 163468
    v_mov_b32 v124, s72
    ds_write_b32 v124, v124
    s_cmp_lg_u32 s3, 3
    s_cbranch_scc1 L_sdone
    v_min_u32 v100, 19, v127
    s_mul_i32 s7, s63, 2560
    s_add_u32 s7, s7, 16326656
    v_lshl_add_u32 v100, v100, 7, s7
    v_lshrrev_b32 v101, 3, v127
    v_and_b32 v102, 7, v127
    v_lshlrev_b32 v103, 12, v101
    v_lshl_add_u32 v103, v102, 4, v103
    v_lshrrev_b32 v104, 1, v102
    v_mul_u32_u24 v104, 2560, v104
    v_lshl_add_u32 v104, v101, 5, v104
    v_and_b32 v102, 1, v102
    v_lshl_add_u32 v104, v102, 4, v104
    v_add_u32 v104, 152576, v104
    s_mul_i32 s76, s63, 327680
    s_lshl_b32 s7, s62, 7
    s_add_u32 s76, s76, s7
    s_add_u32 s76, s76, 13631488
    v_mov_b32 v124, 163456
    s_mov_b32 s73, 0
L_lw51:
    ds_read_b32 v125, v124
    s_add_u32 s73, s73, 1
    s_waitcnt lgkmcnt(0)
    v_cmp_eq_u32 vcc, 0, v125
    s_nop 1
    s_cbranch_vccz L_lw51_ok
    s_sleep 1
    s_cmp_lt_u32 s73, 3200000
    s_cbranch_scc1 L_lw51
L_lw51_ok:
    s_mov_b32 s73, 0
L_poll52:
    buffer_load_dwordx4 v[120:123], v100, s[44:47], 0 offen sc1
    s_waitcnt vmcnt(0)
L_poll52_c:
    v_xor_b32 v120, s60, v120
    v_xor_b32 v121, s60, v121
    v_xor_b32 v122, s60, v122
    v_xor_b32 v123, s60, v123
    v_or_b32 v120, v120, v121
    v_or3_b32 v120, v120, v122, v123
    v_cmp_ne_u32 vcc, 0, v120
    s_nop 1
    s_cbranch_vccz L_poll52_ok
    s_add_u32 s73, s73, 1
    s_sleep 4
    s_cmp_lt_u32 s73, 50000
    s_cbranch_scc1 L_poll52
L_poll52_ok:
    buffer_load_dwordx4 v[40:43], v103, s[44:47], s76 offen sc1
    s_add_u32 s76, s76, 32768
    buffer_load_dwordx4 v[44:47], v103, s[44:47], s76 offen sc1
    s_add_u32 s76, s76, 32768
    buffer_load_dwordx4 v[48:51], v103, s[44:47], s76 offen sc1
    s_add_u32 s76, s76, 32768
    buffer_load_dwordx4 v[52:55], v103, s[44:47], s76 offen sc1
    s_add_u32 s76, s76, 32768
    buffer_load_dwordx4 v[56:59], v103, s[44:47], s76 offen sc1
    s_add_u32 s76, s76, 32768
    buffer_load_dwordx4 v[60:63], v103, s[44:47], s76 offen sc1
    s_add_u32 s76, s76, 32768
    buffer_load_dwordx4 v[64:67], v103, s[44:47], s76 offen sc1
    s_add_u32 s76, s76, 32768
    buffer_load_dwordx4 v[68:71], v103, s[44:47], s76 offen sc1
    s_add_u32 s76, s76, 32768
    buffer_load_dwordx4 v[72:75], v103, s[44:47], s76 offen sc1
    s_add_u32 s76, s76, 32768
    buffer_load_dwordx4 v[76:79], v103, s[44:47], s76 offen sc1
    s_waitcnt vmcnt(9)
    ds_write_b128 v104, v[40:43] offset:0
    s_waitcnt vmcnt(8)
    ds_write_b128 v104, v[44:47] offset:256
    s_waitcnt vmcnt(7)
    ds_write_b128 v104, v[48:51] offset:512
    s_waitcnt vmcnt(6)
    ds_write_b128 v104, v[52:55] offset:768
    s_waitcnt vmcnt(5)
    ds_write_b128 v104, v[56:59] offset:1024
    s_waitcnt vmcnt(4)
    ds_write_b128 v104, v[60:63] offset:1280
    s_waitcnt vmcnt(3)
    ds_write_b128 v104, v[64:67] offset:1536
    s_waitcnt vmcnt(2)
    ds_write_b128 v104, v[68:71] offset:1792
    s_waitcnt vmcnt(1)
    ds_write_b128 v104, v[72:75] offset:2048
    s_waitcnt vmcnt(0)
    ds_write_b128 v104, v[76:79] offset:2304
    v_mov_b32 v124, 163348
    ds_write_b32 v124, v124
L_sdone:
    s_waitcnt lgkmcnt(0)
    s_endpgm
L_end:
    s_endpgm
L_codeend:
.section .rodata,"a"
.p2align 6
.amdhsa_kernel recurrent_scan__ssm_conv_s4__dense_activation_gelu__prompt_kernel
  .amdhsa_next_free_vgpr 256
  .amdhsa_next_free_sgpr 102
  .amdhsa_accum_offset 128
  .amdhsa_group_segment_fixed_size 0
  .amdhsa_kernarg_size 136
  .amdhsa_user_sgpr_count 2
  .amdhsa_user_sgpr_kernarg_segment_ptr 1
  .amdhsa_system_sgpr_workgroup_id_x 1
.end_amdhsa_kernel
```
